```python
import torch

def _softmax(x, axis=-1):
    return torch.softmax(x, dim=axis)

def _gelu(x):
    return torch.nn.functional.gelu(x, approximate='tanh')

def _silu(x):
    return torch.nn.functional.silu(x)

def _sigmoid(x):
    return torch.sigmoid(x)

def _layernorm(x, axis=-1, eps=1e-05):
    m = x.mean(dim=axis, keepdim=True)
    v = x.var(dim=axis, keepdim=True, unbiased=False)
    return (x - m) / torch.sqrt(v + eps)

def _scatter_add(tgt, idx, src, axis=0):
    return tgt.clone().index_add_(axis, idx, src)

def _segment_sum(src, seg, n):
    out = torch.zeros((n,) + src.shape[1:], dtype=src.dtype)
    return out.index_add_(0, seg, src)

def _pad(x, pw):
    flat = tuple((v for pair in reversed(pw) for v in pair))
    return torch.nn.functional.pad(x, flat)
kernel_name = 'adaLN_cond__linear_kernel_hedgehog__mixer_gmlp__prompt'

def setup_inputs():

    _w = lambda a: (lambda t: t.to(torch.bfloat16) if t.is_floating_point() else t)(torch.as_tensor(a))

    def _A_setup():
        B, S, D, H = (1, 2048, 448, 16)
        Dh = D // H
        return {'x': _w((lambda *s: torch.randn(*s, dtype=torch.bfloat16) * 0.05)(B, S, D)), 'wqkv': _w((lambda *s: torch.randn(*s, dtype=torch.bfloat16) * 0.4)(D, 3 * D)), 'w_phi': _w((lambda *s: torch.randn(*s, dtype=torch.bfloat16) * 0.4)(H, Dh, Dh) * Dh ** (-0.5)), 'wo': _w((lambda *s: torch.randn(*s, dtype=torch.bfloat16) * 0.1)(D, D))}
    _A_in = _A_setup()

    def _B_setup():
        B, S, D, F = (1, 2048, 448, 1792)
        Fh = F // 2
        return {'x': _w((lambda *s: torch.randn(*s, dtype=torch.bfloat16) * 0.05)(B, S, D)), 'w_in': _w((lambda *s: torch.randn(*s, dtype=torch.bfloat16) * 0.4)(D, 2 * Fh)), 'w_sp': _w(0.01 * (lambda *s: torch.randn(*s, dtype=torch.bfloat16) * 0.4)(S, S)), 'b_sp': _w(1.0 + 0.01 * (lambda *s: torch.randn(*s, dtype=torch.bfloat16) * 0.05)(S)), 'w_out': _w((lambda *s: torch.randn(*s, dtype=torch.bfloat16) * 0.05)(Fh, D))}
    _B_in = _B_setup()
    return {'A_x': _A_in['x'], 'A_wqkv': _A_in['wqkv'], 'A_w_phi': _A_in['w_phi'], 'A_wo': _A_in['wo'], 'B_x': _B_in['x'], 'B_w_in': _B_in['w_in'], 'B_w_sp': _B_in['w_sp'], 'B_b_sp': _B_in['b_sp'], 'B_w_out': _B_in['w_out'], 'c': _w((lambda *s: torch.randn(*s, dtype=torch.bfloat16) * 0.2)(1, 448) * 8.0), 'w_mod': _w((lambda *s: torch.randn(*s, dtype=torch.bfloat16) * 0.2)(448, 6 * 448) * 448 ** (-0.5) * 8.0)}

def reference(A_x, A_wqkv, A_w_phi, A_wo, B_x, B_w_in, B_w_sp, B_b_sp, B_w_out, c, w_mod):

    def _A_ref(x, wqkv, w_phi, wo):
        B, S, D = x.shape
        H = 16
        Dh = D // H
        qkv = (lambda x, *d: x.permute(*d))((x @ wqkv).reshape(B, S, 3, H, Dh), 2, 0, 3, 1, 4)
        q, k, v = (qkv[0], qkv[1], qkv[2])
        pq = torch.einsum('bhsd,hdf->bhsf', q, w_phi)
        pk = torch.einsum('bhsd,hdf->bhsf', k, w_phi)
        phi_q = torch.concatenate([_softmax(pq, axis=-1), _softmax(-pq, axis=-1)], axis=-1)
        phi_k = torch.concatenate([_softmax(pk, axis=-1), _softmax(-pk, axis=-1)], axis=-1)
        kv = torch.einsum('bhsf,bhsd->bhfd', phi_k, v)
        z = torch.einsum('bhsf->bhf', phi_k)
        num = torch.einsum('bhqf,bhfd->bhqd', phi_q, kv)
        den = torch.einsum('bhqf,bhf->bhq', phi_q, z)[..., None] + 1e-06
        o = num / den
        return (lambda x, *d: x.permute(*d))(o, 0, 2, 1, 3).reshape(B, S, D) @ wo

    def _B_ref(x, w_in, w_sp, b_sp, w_out):
        B, S, D = x.shape
        F = w_in.shape[-1]
        Fh = F // 2
        z = _gelu(torch.einsum('bsd,df->bsf', x, w_in))
        z1 = z[..., :Fh].clone()
        z2 = _layernorm(z[..., Fh:], axis=-1)
        g = torch.einsum('ts,bsf->btf', w_sp, z2) + b_sp[None, :, None]
        return torch.einsum('bsf,fd->bsd', z1 * g, w_out)
    x = A_x
    mod = (_silu(c) @ w_mod).reshape(c.shape[0], 6, 1, -1)
    sa, ca, ga, sb, cb, gb = (mod[:, 0].clone(), mod[:, 1].clone(), mod[:, 2].clone(), mod[:, 3].clone(), mod[:, 4].clone(), mod[:, 5].clone())
    h = _layernorm(x, axis=-1) * (1 + ca) + sa
    x = x + ga * _A_ref(h, A_wqkv, A_w_phi, A_wo)
    h = _layernorm(x, axis=-1) * (1 + cb) + sb
    x = x + gb * _B_ref(h, B_w_in, B_w_sp, B_b_sp, B_w_out)
    return x
```

```asm
; @launch grid=(256,1,1) block=(256,1,1) lds=163840
.amdgcn_target "amdgcn-amd-amdhsa--gfx950"
.text
.p2align 12
.globl adaLN_cond__linear_kernel_hedgehog__mixer_gmlp__prompt_kernel
.p2align 8
.type adaLN_cond__linear_kernel_hedgehog__mixer_gmlp__prompt_kernel,@function
adaLN_cond__linear_kernel_hedgehog__mixer_gmlp__prompt_kernel:
    s_cmp_ge_u32 s2, 256
    s_cbranch_scc1 L_done
    s_load_dwordx2 s[48:49], s[0:1], 104
    s_load_dwordx2 s[36:37], s[0:1], 72
    s_load_dwordx2 s[40:41], s[0:1], 80
    s_load_dwordx2 s[8:9], s[0:1], 8
    s_load_dwordx2 s[20:21], s[0:1], 40
    s_load_dwordx2 s[4:5], s[0:1], 0
    s_load_dwordx2 s[12:13], s[0:1], 16
    s_getpc_b64 s[78:79]
L_pc:
    s_lshr_b32 s61, s2, 3
    s_lshl_b32 s64, s61, 11
    v_lshl_add_u32 v5, v0, 7, s64
    v_min_u32 v5, L_done-L_pc, v5
    v_cmp_gt_u32 vcc, 16, v0
    s_nop 0
    s_and_saveexec_b64 s[80:81], vcc
    s_cbranch_execz L_nocode
    global_load_dword v239, v5, s[78:79]
L_nocode:
    s_mov_b64 exec, -1
    v_lshrrev_b32 v4, 6, v0
    v_and_b32 v0, 63, v0
    v_readfirstlane_b32 s52, v4
    s_and_b32 s60, s2, 7
    s_and_b32 s89, s61, 3
    s_lshr_b32 s64, s61, 2
    s_mul_i32 s65, s64, 3
    s_add_u32 s65, s65, s89
    s_cmp_eq_u32 s89, 3
    s_cselect_b32 s64, s64, s65
    s_cselect_b32 s65, 7, 14
    s_cselect_b32 s66, 0, 56
    s_mul_i32 s80, s60, s65
    s_add_u32 s80, s80, s66
    s_add_u32 s80, s80, s64
    s_cmp_lt_u32 s64, s65
    s_cselect_b32 s86, 0, 21
    s_and_b32 s81, s80, 3
    s_lshr_b32 s80, s80, 2
    s_mul_i32 s67, s81, 224
    s_mul_i32 s68, s81, 602112
    s_lshl_b32 s69, s80, 7
    s_add_u32 s68, s68, s69
    s_mul_i32 s69, s52, 172032
    s_add_u32 s68, s68, s69
    s_cmp_ge_u32 s86, 21
    s_cselect_b32 s68, 2130706432, s68
    s_lshl_b32 s69, s52, 12
    v_cmp_gt_u32 vcc, 56, v0
    v_lshlrev_b32 v5, 2, v0
    v_mov_b32 v15, 2130706432
    v_cndmask_b32 v5, v15, v5, vcc
    s_mov_b32 s50, 25165824
    s_mov_b32 s51, 0x00020000
    s_mov_b32 s38, 896
    s_mov_b32 s39, 0x00020000
    s_mov_b32 s42, 2408448
    s_mov_b32 s43, 0x00020000
    v_lshrrev_b32 v228, 3, v0
    v_and_b32 v229, 6, v228
    v_mul_u32_u24 v228, 5376, v228
    v_xor_b32 v229, v229, v0
    v_and_b32 v229, 7, v229
    v_lshl_add_u32 v228, v229, 4, v228
    v_add_u32 v229, 41984, v228
    v_add_u32 v230, 83968, v228
    v_add_u32 v231, 125952, v228
    s_waitcnt lgkmcnt(0)
    buffer_load_dword v233, v5, s[36:39], s67 offen
    buffer_load_dword v232, off, s[48:51], 0 sc1
    s_add_u32 m0, s69, 61440
    s_add_u32 s76, s68, 0
    buffer_load_dwordx4 v228, s[40:43], s76 offen nt lds
    buffer_load_dwordx4 v229, s[40:43], s76 offen offset:1024 nt lds
    buffer_load_dwordx4 v230, s[40:43], s76 offen offset:2048 nt lds
    buffer_load_dwordx4 v231, s[40:43], s76 offen offset:3072 nt lds
    s_lshl2_add_u32 s64, s80, s52
    s_mul_i32 s65, s64, 37
    s_lshr_b32 s65, s65, 8
    s_mul_i32 s66, s65, 7
    s_sub_u32 s66, s64, s66
    s_lshl2_add_u32 s66, s66, s81
    s_lshl2_add_u32 s65, s66, s65
    s_cmp_lt_u32 s66, 16
    s_cselect_b32 s65, s65, 736
    s_cmp_lt_u32 s64, 28
    s_cselect_b32 s65, s65, 736
    s_lshl2_add_u32 s64, s64, s81
    s_mul_i32 s64, s64, 3
    s_add_u32 s64, s64, 63
    v_add_u32 v4, s64, v0
    v_writelane_b32 v4, s65, 0
    v_cmp_gt_u32 vcc, 736, v4
    v_lshlrev_b32 v4, 7, v4
    v_mov_b32 v5, 0
    v_cndmask_b32 v4, v15, v4, vcc
    s_mov_b32 s64, 786432
    s_cmp_ge_u32 s86, 21
    s_cselect_b32 s64, 2130706432, s64
    s_mov_b64 exec, 15
    buffer_store_dword v5, v4, s[48:51], s64 offen sc1
    s_mov_b64 exec, -1
    s_mov_b32 s10, 1204224
    s_mov_b32 s11, 0x00020000
    s_mov_b32 s22, 1605632
    s_mov_b32 s23, 0x00020000
    s_mov_b32 s6, 1835008
    s_mov_b32 s7, 0x00020000
    s_mov_b32 s14, 25088
    s_mov_b32 s15, 0x00020000
    v_lshlrev_b32 v1, 4, v0
    s_and_b32 s64, s60, 3
    s_lshr_b32 s65, s60, 2
    s_and_b32 s66, s61, 7
    s_lshr_b32 s70, s61, 3
    s_mul_i32 s64, s64, 4
    s_add_u32 s54, s64, s70
    s_mul_i32 s65, s65, 8
    s_add_u32 s55, s65, s66
    s_lshr_b32 s87, s55, 2
    s_add_u32 s64, s89, 1
    s_cmp_eq_u32 s89, 2
    s_cselect_b32 s64, 0, s64
    s_mul_i32 s64, s64, 896
    s_mul_i32 s65, s54, 56
    s_add_u32 s64, s64, s65
    s_mul_i32 s65, s87, 301056
    s_add_u32 s64, s64, s65
    s_mul_i32 s65, s52, 86016
    s_add_u32 s83, s64, s65
    s_lshl_b32 s66, s52, 11
    s_add_u32 m0, s66, 78848
    s_cmp_eq_u32 s89, 3
    s_cselect_b32 s83, 2130706432, s83
    v_lshrrev_b32 v226, 2, v0
    v_mul_u32_u24 v224, 2688, v226
    v_and_b32 v4, 3, v0
    v_lshl_add_u32 v224, v4, 4, v224
    buffer_load_dwordx4 v224, s[8:11], s83 offen lds
    v_add_u32 v225, 41984, v224
    buffer_load_dwordx4 v225, s[8:11], s83 offen offset:1024 lds
    s_mul_i32 s76, s54, 1568
    s_min_u32 s65, s52, 1
    s_lshl_b32 s65, s65, 10
    s_add_u32 m0, s65, 157696
    s_add_u32 s76, s76, s65
    buffer_load_dwordx4 v1, s[12:15], s76 offen lds
    v_and_b32 v6, 31, v0
    v_lshrrev_b32 v7, 5, v0
    v_cmp_gt_u32 vcc, 28, v6
    v_lshlrev_b32 v6, 4, v6
    v_mul_u32_u24 v7, 896, v7
    v_add_u32 v6, v6, v7
    v_cndmask_b32 v6, v15, v6, vcc
    s_lshl_b32 s85, s55, 4
    s_add_u32 s85, s85, s54
    s_lshl2_add_u32 s85, s85, s52
    s_mul_i32 s70, s85, 1792
    s_mov_b32 s74, 0xffff0000
    buffer_load_dwordx4 v[196:199], v6, s[4:7], s70 offen
    buffer_load_dwordx4 v[200:203], v6, s[4:7], s70 offen offset:448
    v_lshrrev_b32 v78, 2, v0
    v_bfe_u32 v79, v78, 1, 2
    v_lshlrev_b32 v78, 7, v78
    v_lshl_add_u32 v78, v79, 5, v78
    v_and_b32 v79, 3, v0
    v_lshl_add_u32 v78, v79, 3, v78
    v_lshrrev_b32 v76, 4, v0
    v_lshlrev_b32 v74, 6, v76
    v_bfe_u32 v75, v0, 1, 2
    v_lshl_add_u32 v74, v75, 4, v74
    v_bfe_u32 v75, v0, 3, 1
    v_lshl_add_u32 v74, v75, 3, v74
    v_and_b32 v75, 1, v0
    v_lshl_add_u32 v74, v75, 2, v74
    s_lshl_b32 s64, s52, 8
    s_add_u32 s64, s64, 77824
    v_add_u32 v74, s64, v74
    v_lshl_add_u32 v75, v76, 4, s64
    s_lshl_b32 s64, s52, 5
    v_xor_b32 v78, s64, v78
    v_add_u32 v78, 61440, v78
    s_mul_i32 s65, s81, 10752
    s_lshl2_add_u32 s64, s80, s52
    s_lshl_b32 s64, s64, 6
    s_add_u32 s65, s65, s64
    s_add_u32 s65, s65, 720896
    s_cmp_ge_u32 s86, 21
    s_cselect_b32 s65, 2130706432, s65
    s_mov_b32 s66, 0x07060500
    s_mov_b32 s67, 0x07060501
    s_mov_b32 s68, 0x07060502
    s_mov_b32 s69, 0x07060503
    s_waitcnt vmcnt(11)
    v_lshlrev_b32 v70, 16, v233
    v_and_b32 v71, s74, v233
    v_mul_f32 v72, 0xbfb8aa3b, v70
    v_mul_f32 v73, 0xbfb8aa3b, v71
    v_exp_f32 v72, v72
    v_exp_f32 v73, v73
    v_add_f32 v72, 1.0, v72
    v_add_f32 v73, 1.0, v73
    v_rcp_f32 v72, v72
    v_rcp_f32 v73, v73
    v_mul_f32 v70, v70, v72
    v_mul_f32_e64 v71, v71, v73
    v_cvt_pk_bf16_f32 v70, v70, v71
    ds_write_b32 v74, v70
    ds_read_b128 v[80:83], v75 offset:0
    ds_read_b128 v[84:87], v75 offset:64
    ds_read_b128 v[88:91], v75 offset:128
    ds_read_b128 v[92:95], v75 offset:192
    s_waitcnt vmcnt(10)
    v_readfirstlane_b32 s64, v232
    s_nop 0
    s_mul_i32 s53, s64, 0x2c9277b5
    s_add_u32 s53, s53, 0xac564b05
    s_xor_b32 s64, s64, s53
    s_and_b32 s64, s64, 0x9fff0000
    s_cselect_b32 s64, 0, 0x10000
    s_xor_b32 s53, s53, s64
    s_or_b32 s53, s53, 2
    v_mov_b32_e64 v3, s53
    s_waitcnt vmcnt(5)
    s_barrier
    ds_read_b64_tr_b16 v[96:97], v78 offset:0
    ds_read_b64_tr_b16 v[98:99], v78 offset:2048
    ds_read_b64_tr_b16 v[100:101], v78 offset:4096
    ds_read_b64_tr_b16 v[102:103], v78 offset:6144
    ds_read_b64_tr_b16 v[104:105], v78 offset:8192
    ds_read_b64_tr_b16 v[106:107], v78 offset:10240
    ds_read_b64_tr_b16 v[108:109], v78 offset:12288
    ds_read_b64_tr_b16 v[110:111], v78 offset:14336
    v_lshrrev_b32 v15, 3, v0
    v_lshrrev_b32 v220, 4, v0
    v_xor_b32 v220, v220, v0
    v_and_b32 v220, 7, v220
    v_lshlrev_b32 v220, 4, v220
    v_mul_u32_u24 v15, 896, v15
    v_xor_b32 v221, 64, v220
    v_add_u32 v220, v220, v15
    s_waitcnt lgkmcnt(6)
    v_mfma_f32_16x16x32_bf16 v[72:75], v[96:99], v[80:83], 0
    s_waitcnt lgkmcnt(4)
    v_mfma_f32_16x16x32_bf16 v[72:75], v[100:103], v[84:87], v[72:75]
    s_waitcnt lgkmcnt(2)
    v_mfma_f32_16x16x32_bf16 v[72:75], v[104:107], v[88:91], v[72:75]
    s_waitcnt lgkmcnt(0)
    v_mfma_f32_16x16x32_bf16 v[72:75], v[108:111], v[92:95], v[72:75]
    v_add_u32 v221, v221, v15
    v_add_u32 v221, 6144, v221
    v_add_u32 v222, 12288, v220
    v_add_u32 v223, 12288, v221
    s_lshl2_add_u32 s88, s55, s52
    s_mul_i32 s82, s88, 28672
    s_lshl_b32 s73, s52, 14
    s_add_u32 s73, s73, 92160
    s_mov_b32 exec_lo, 0x00010001
    s_mov_b32 exec_hi, 0x00010001
    v_perm_b32 v72, v72, v3, s66
    v_perm_b32 v73, v73, v3, s67
    v_perm_b32 v74, v74, v3, s68
    v_perm_b32 v75, v75, v3, s69
    buffer_store_dwordx4 v[72:75], v0, s[48:51], s65 offen sc1
    s_mov_b64 exec, -1
    v_and_b32 v15, 31, v0
    s_add_u32 m0, s73, 0
    s_add_u32 s76, s82, 0
    v_lshrrev_b32 v5, 5, v0
    v_lshlrev_b32 v8, 9, v5
    buffer_load_dwordx4 v220, s[4:7], s76 offen lds
    s_mul_i32 s65, s52, 896
    s_add_u32 s65, s65, 159744
    v_lshl_add_u32 v22, v5, 5, s65
    buffer_load_dwordx4 v221, s[4:7], s76 offen offset:1024 lds
    v_lshl_add_u32 v23, v5, 4, s65
    v_min_u32 v15, 27, v15
    v_lshl_add_u32 v236, v15, 4, s65
    buffer_load_dwordx4 v222, s[4:7], s76 offen offset:2048 lds
    v_lshl_add_u32 v237, v15, 3, s65
    v_mul_u32_u24 v6, 224, v5
    v_add_u32 v237, v237, v6
    buffer_load_dwordx4 v223, s[4:7], s76 offen offset:3072 lds
    v_sub_u32 v6, 1, v5
    v_cvt_f32_u32 v238, v6
    v_mul_u32_u24 v6, 1792, v6
    v_lshl_add_u32 v234, v15, 4, v6
    v_and_b32 v15, 1, v0
    v_mul_u32_u24 v6, 224, v15
    s_add_u32 m0, s73, 4096
    s_add_u32 s76, s82, 128
    v_add_u32 v23, v23, v6
    v_bfe_u32 v15, v0, 2, 2
    v_lshl_add_u32 v8, v15, 6, v8
    buffer_load_dwordx4 v220, s[4:7], s76 offen lds
    v_bfe_u32 v15, v0, 4, 1
    v_lshl_add_u32 v8, v15, 5, v8
    v_and_b32 v15, 3, v0
    buffer_load_dwordx4 v221, s[4:7], s76 offen offset:1024 lds
    v_lshl_add_u32 v8, v15, 3, v8
    v_add_u32 v9, 78848, v8
    s_lshl_b32 s64, s52, 11
    buffer_load_dwordx4 v222, s[4:7], s76 offen offset:2048 lds
    v_add_u32 v10, s64, v9
    s_mul_i32 s84, s52, 7168
    s_lshl_b32 s64, s52, 7
    buffer_load_dwordx4 v223, s[4:7], s76 offen offset:3072 lds
    v_add_u32 v233, s64, v22
    s_and_b32 s12, s53, 0xff
    s_bfe_u32 s13, s53, 0x80008
    s_bfe_u32 s14, s53, 0x80010
    s_lshr_b32 s15, s53, 24
    s_waitcnt vmcnt(12)
    s_waitcnt lgkmcnt(0)
    s_barrier
    ds_read_b64_tr_b16 v[32:33], v10 offset:0
    ds_read_b64_tr_b16 v[34:35], v10 offset:256
    ds_read_b64_tr_b16 v[36:37], v10 offset:1024
    ds_read_b64_tr_b16 v[38:39], v10 offset:1280
    ds_read_b64_tr_b16 a[64:65], v9 offset:0
    ds_read_b64_tr_b16 a[66:67], v9 offset:256
    ds_read_b64_tr_b16 a[68:69], v9 offset:1024
    ds_read_b64_tr_b16 a[70:71], v9 offset:1280
    ds_read_b64_tr_b16 a[72:73], v9 offset:2048
    ds_read_b64_tr_b16 a[74:75], v9 offset:2304
    ds_read_b64_tr_b16 a[76:77], v9 offset:3072
    ds_read_b64_tr_b16 a[78:79], v9 offset:3328
    ds_read_b64_tr_b16 a[80:81], v9 offset:4096
    ds_read_b64_tr_b16 a[82:83], v9 offset:4352
    ds_read_b64_tr_b16 a[84:85], v9 offset:5120
    ds_read_b64_tr_b16 a[86:87], v9 offset:5376
    ds_read_b64_tr_b16 a[88:89], v9 offset:6144
    ds_read_b64_tr_b16 a[90:91], v9 offset:6400
    s_waitcnt lgkmcnt(15)
    v_lshlrev_b32 v60, 16, v32
    v_and_b32 v61, s74, v32
    v_lshlrev_b32 v62, 16, v33
    v_and_b32 v63, s74, v33
    v_lshlrev_b32 v64, 16, v34
    v_and_b32 v65, s74, v34
    v_lshlrev_b32 v66, 16, v35
    v_and_b32 v67, s74, v35
    v_lshlrev_b32 v68, 16, v36
    v_and_b32 v69, s74, v36
    v_lshlrev_b32 v70, 16, v37
    v_and_b32 v71, s74, v37
    s_waitcnt lgkmcnt(14)
    v_lshlrev_b32 v72, 16, v38
    v_and_b32 v73, s74, v38
    v_lshlrev_b32 v74, 16, v39
    v_and_b32 v75, s74, v39
    s_lshl_b32 s70, s85, 5
    s_add_u32 s70, s70, 32768
    s_mul_i32 s66, s87, 448
    s_add_u32 s66, s66, 720896
    s_add_u32 s67, s66, 10752
    s_add_u32 s68, s66, 21504
    s_add_u32 s69, s66, 32256
    s_mul_i32 s83, s54, 92160
    s_add_u32 s83, s83, 23068672
    s_mul_i32 s64, s89, 30720
    s_add_u32 s64, s64, s83
    s_mul_i32 s65, s87, 7168
    s_lshl_b32 s71, s52, 11
    s_add_u32 s65, s65, s71
    s_add_u32 s80, s64, s65
    s_lshl_b32 s65, s87, 9
    s_add_u32 s64, s64, s65
    s_add_u32 s64, s64, 28672
    s_lshl2_add_u32 s75, s54, s87
    s_lshl_b32 s75, s75, 7
    s_add_u32 s75, s75, 786432
    s_cmp_eq_u32 s52, 3
    s_cselect_b32 s81, 2130706432, s80
    s_cselect_b32 s85, s64, 2130706432
    s_cmp_eq_u32 s52, 0
    s_cbranch_scc1 L_stub0
    s_cmp_eq_u32 s52, 1
    s_cbranch_scc1 L_stub1
    s_cmp_eq_u32 s52, 2
    s_cbranch_scc1 L_stub2
    s_branch L_stub3
L_walked:
    s_cmp_eq_u32 s89, 3
    s_cselect_b32 s75, 2130706432, s75
    s_cbranch_scc1 L_skipunit1
    s_mov_b32 s72, 524288
L_poll1:
    buffer_load_dwordx4 v[172:175], v234, s[48:51], s66 offen sc1
    buffer_load_dwordx4 v[176:179], v234, s[48:51], s67 offen sc1
    buffer_load_dwordx4 v[180:183], v234, s[48:51], s68 offen sc1
    buffer_load_dwordx4 v[184:187], v234, s[48:51], s69 offen sc1
    s_sub_u32 s72, s72, 1
    s_cbranch_scc1 L_pollx1
    s_waitcnt vmcnt(0)
    v_xor_b32 v172, s12, v172
    v_xor_b32 v173, s13, v173
    v_xor_b32 v174, s14, v174
    v_xor_b32 v175, s15, v175
    v_xor_b32 v176, s12, v176
    v_xor_b32 v177, s13, v177
    v_xor_b32 v178, s14, v178
    v_xor_b32 v179, s15, v179
    v_xor_b32 v180, s12, v180
    v_xor_b32 v181, s13, v181
    v_xor_b32 v182, s14, v182
    v_xor_b32 v183, s15, v183
    v_xor_b32 v184, s12, v184
    v_xor_b32 v185, s13, v185
    v_xor_b32 v186, s14, v186
    v_xor_b32_e64 v187, s15, v187
    v_or3_b32 v15, v172, v173, v174
    v_or3_b32 v15, v15, v175, v176
    v_or3_b32 v15, v15, v177, v178
    v_or3_b32 v15, v15, v179, v180
    v_or3_b32 v15, v15, v181, v182
    v_or3_b32 v15, v15, v183, v184
    v_or3_b32 v15, v15, v185, v186
    v_or_b32 v15, v15, v187
    v_and_b32 v15, 0xff, v15
    v_cmp_ne_u32 vcc, 0, v15
    s_nop 0
    s_cbranch_vccnz L_poll1
L_pollx1:
    v_pk_add_f32 v[172:173], v[172:173], v[180:181]
    v_pk_add_f32 v[174:175], v[174:175], v[182:183]
    v_pk_add_f32 v[176:177], v[176:177], v[184:185]
    v_pk_add_f32 v[178:179], v[178:179], v[186:187]
    v_pk_add_f32 v[172:173], v[172:173], v[176:177]
    v_pk_add_f32 v[174:175], v[174:175], v[178:179]
    v_cvt_pk_bf16_f32 v176, v172, v173
    v_cvt_pk_bf16_f32 v177, v174, v175
    v_lshlrev_b32 v172, 16, v176
    v_and_b32 v173, s74, v176
    v_lshlrev_b32 v174, 16, v177
    v_and_b32 v175, s74, v177
    v_add_f32 v172, v172, v238
    v_add_f32 v173, v173, v238
    v_add_f32 v174, v174, v238
    v_add_f32 v175, v175, v238
    v_cvt_pk_bf16_f32 v176, v172, v173
    v_cvt_pk_bf16_f32 v177, v174, v175
    v_lshlrev_b32 v172, 16, v176
    v_and_b32 v173, s74, v176
    v_lshlrev_b32 v174, 16, v177
    v_and_b32 v175, s74, v177
    s_mov_b32 exec_hi, 0
    ds_write_b128 v236, v[172:175]
    s_mov_b32 exec_hi, -1
    ds_write_b64 v237, v[176:177] offset:448
    ds_read_b128 a[0:3], v23 offset:448
    ds_read_b128 a[4:7], v23 offset:480
    ds_read_b128 v[116:119], v233 offset:0
    ds_read_b128 v[120:123], v233 offset:16
    ds_read_b128 a[8:11], v23 offset:512
    ds_read_b128 a[12:15], v23 offset:544
    ds_read_b128 a[16:19], v23 offset:576
    ds_read_b128 v[124:127], v233 offset:64
    ds_read_b128 v[128:131], v233 offset:80
    ds_read_b128 a[20:23], v23 offset:608
    ds_read_b128 a[24:27], v23 offset:640
    s_waitcnt lgkmcnt(10)
    v_mfma_f32_32x32x16_bf16 v[204:219], a[0:3], a[64:67], 0
    s_waitcnt lgkmcnt(8)
    v_mul_f32 v60, v60, v116
    v_mul_f32 v61, v61, v117
    v_cvt_pk_bf16_f32 v244, v60, v61
    v_mfma_f32_32x32x16_bf16 v[204:219], a[4:7], a[68:71], v[204:219]
    v_mul_f32 v62, v62, v118
    v_mul_f32 v63, v63, v119
    v_cvt_pk_bf16_f32 v245, v62, v63
    s_waitcnt lgkmcnt(6)
    v_mfma_f32_32x32x16_bf16 v[204:219], a[8:11], a[72:75], v[204:219]
    v_mul_f32 v64, v64, v120
    v_mul_f32 v65, v65, v121
    s_waitcnt lgkmcnt(5)
    v_mfma_f32_32x32x16_bf16 v[204:219], a[12:15], a[76:79], v[204:219]
    v_cvt_pk_bf16_f32 v246, v64, v65
    v_mul_f32 v66, v66, v122
    v_mul_f32 v67, v67, v123
    s_waitcnt lgkmcnt(4)
    v_mfma_f32_32x32x16_bf16 v[204:219], a[16:19], a[80:83], v[204:219]
    v_cvt_pk_bf16_f32 v247, v66, v67
    buffer_store_dwordx4 v[244:247], v1, s[48:51], s80 offen sc1
    s_waitcnt lgkmcnt(3)
    v_mul_f32 v68, v68, v124
    s_waitcnt lgkmcnt(1)
    v_mfma_f32_32x32x16_bf16 v[204:219], a[20:23], a[84:87], v[204:219]
    v_mul_f32 v69, v69, v125
    v_cvt_pk_bf16_f32 v248, v68, v69
    s_waitcnt lgkmcnt(0)
    v_mfma_f32_32x32x16_bf16 v[204:219], a[24:27], a[88:91], v[204:219]
    s_branch L_page0
.p2align 12
L_stub0:
    s_branch L_stub4
L_page0:
    v_mul_f32 v70, v70, v126
    v_mul_f32 v71, v71, v127
    v_cvt_pk_bf16_f32 v249, v70, v71
    v_mul_f32 v72, v72, v128
    v_mul_f32 v73, v73, v129
    v_cvt_pk_bf16_f32 v250, v72, v73
    v_mul_f32 v74, v74, v130
    v_mul_f32 v75, v75, v131
    v_cvt_pk_bf16_f32 v251, v74, v75
    buffer_store_dwordx4 v[248:251], v1, s[48:51], s81 offen offset:1024 sc1
    s_nop 1
    v_cvt_pk_bf16_f32 v116, v204, v205
    v_lshlrev_b32 v60, 16, v116
    v_sub_f32 v204, v204, v60
    v_and_b32 v60, s74, v116
    v_sub_f32 v205, v205, v60
    v_cvt_pk_bf16_f32 v118, v204, v205
    v_mov_b32 v117, v116
    v_mov_b32 v119, 0
    s_mov_b32 exec_hi, 0
    buffer_store_dwordx4 v[116:119], v1, s[48:51], s85 offen sc1
    s_mov_b32 exec_hi, -1
L_nounit1:
    v_lshlrev_b32 v76, 16, v196
    s_add_u32 m0, s73, 8192
    s_add_u32 s76, s82, 256
    v_and_b32 v77, s74, v196
    v_lshlrev_b32 v78, 16, v197
    v_and_b32 v79, s74, v197
    v_lshlrev_b32 v80, 16, v198
    v_and_b32 v81, s74, v198
    buffer_load_dwordx4 v220, s[4:7], s76 offen lds
    v_lshlrev_b32 v82, 16, v199
    v_and_b32 v83, s74, v199
    v_lshlrev_b32 v84, 16, v200
    v_and_b32 v85, s74, v200
    v_lshlrev_b32 v86, 16, v201
    buffer_load_dwordx4 v221, s[4:7], s76 offen offset:1024 lds
    v_and_b32 v87, s74, v201
    v_lshlrev_b32 v88, 16, v202
    v_and_b32 v89, s74, v202
    v_lshlrev_b32 v90, 16, v203
    v_and_b32 v91, s74, v203
    buffer_load_dwordx4 v222, s[4:7], s76 offen offset:2048 lds
    v_pk_add_f32 v[92:93], v[76:77], v[78:79]
    v_pk_add_f32 v[92:93], v[92:93], v[80:81]
    v_pk_add_f32 v[92:93], v[92:93], v[82:83]
    v_pk_add_f32 v[92:93], v[92:93], v[84:85]
    v_pk_add_f32 v[92:93], v[92:93], v[86:87]
    buffer_load_dwordx4 v223, s[4:7], s76 offen offset:3072 lds
    v_pk_add_f32 v[92:93], v[92:93], v[88:89]
    v_pk_add_f32 v[92:93], v[92:93], v[90:91]
    v_add_f32 v92, v92, v93
    s_nop 1
    v_add_f32_dpp v92, v92, v92 quad_perm:[1,0,3,2] row_mask:0xf bank_mask:0xf
    v_and_b32 v15, 31, v0
    v_lshrrev_b32 v4, 1, v15
    v_add_f32_dpp v92, v92, v92 quad_perm:[2,3,0,1] row_mask:0xf bank_mask:0xf
    v_lshrrev_b32 v5, 5, v0
    v_xor_b32 v4, v4, v5
    v_add_f32_dpp v92, v92, v92 row_half_mirror row_mask:0xf bank_mask:0xf
    s_add_u32 m0, s73, 12288
    s_add_u32 s76, s82, 384
    v_and_b32 v4, 7, v4
    v_lshlrev_b32 v4, 4, v4
    v_add_f32_dpp v92, v92, v92 row_mirror row_mask:0xf bank_mask:0xf
    v_lshl_add_u32 v4, v15, 7, v4
    v_add_u32 v4, s73, v4
    buffer_load_dwordx4 v220, s[4:7], s76 offen lds
    v_mov_b32 v93, v92
    v_mul_u32_u24 v12, 240, v15
    v_lshl_add_u32 v12, v5, 4, v12
    v_permlane16_swap_b32 v92, v93
    v_lshlrev_b32 v235, 4, v15
    buffer_load_dwordx4 v221, s[4:7], s76 offen offset:1024 lds
    v_xor_b32 v5, 32, v4
    v_add_f32 v92, v92, v93
    v_mul_f32 v92, 0xbb124925, v92
    v_and_b32 v93, 31, v0
    v_cmp_gt_u32 vcc, 28, v93
    buffer_load_dwordx4 v222, s[4:7], s76 offen offset:2048 lds
    v_xor_b32 v6, 64, v4
    v_xor_b32 v7, 96, v4
    v_cndmask_b32 v94, 0, v92, vcc
    v_cndmask_b32_e64 v95, 0, v92, vcc
    v_pk_add_f32 v[76:77], v[76:77], v[94:95]
    buffer_load_dwordx4 v223, s[4:7], s76 offen offset:3072 lds
    v_pk_add_f32 v[78:79], v[78:79], v[94:95]
    v_pk_add_f32 v[80:81], v[80:81], v[94:95]
    v_pk_add_f32 v[82:83], v[82:83], v[94:95]
    v_pk_add_f32 v[84:85], v[84:85], v[94:95]
    v_pk_add_f32 v[86:87], v[86:87], v[94:95]
    v_pk_add_f32 v[88:89], v[88:89], v[94:95]
    v_pk_add_f32 v[90:91], v[90:91], v[94:95]
    v_pk_mul_f32 v[96:97], v[76:77], v[76:77]
    v_pk_fma_f32 v[96:97], v[78:79], v[78:79], v[96:97]
    v_pk_fma_f32 v[96:97], v[80:81], v[80:81], v[96:97]
    v_pk_fma_f32 v[96:97], v[82:83], v[82:83], v[96:97]
    v_pk_fma_f32 v[96:97], v[84:85], v[84:85], v[96:97]
    v_pk_fma_f32 v[96:97], v[86:87], v[86:87], v[96:97]
    v_pk_fma_f32 v[96:97], v[88:89], v[88:89], v[96:97]
    v_pk_fma_f32 v[96:97], v[90:91], v[90:91], v[96:97]
    v_add_f32 v95, v96, v97
    s_nop 1
    v_add_f32_dpp v95, v95, v95 quad_perm:[1,0,3,2] row_mask:0xf bank_mask:0xf
    ds_read_b128 a[128:131], v4 offset:0
    s_nop 0
    v_add_f32_dpp v95, v95, v95 quad_perm:[2,3,0,1] row_mask:0xf bank_mask:0xf
    ds_read_b128 a[132:135], v5 offset:0
    ds_read_b128 a[136:139], v6 offset:0
    v_add_f32_dpp v95, v95, v95 row_half_mirror row_mask:0xf bank_mask:0xf
    ds_read_b128 a[140:143], v7 offset:0
    s_nop 0
    v_add_f32_dpp v95, v95, v95 row_mirror row_mask:0xf bank_mask:0xf
    ds_read_b128 a[144:147], v4 offset:4096
    ds_read_b128 a[148:151], v5 offset:4096
    v_mov_b32 v96, v95
    ds_read_b128 a[152:155], v6 offset:4096
    ds_read_b128 a[156:159], v7 offset:4096
    v_permlane16_swap_b32 v95, v96
    v_add_f32 v95, v95, v96
    v_mov_b32 v96, 0x3727c5ac
    v_fmac_f32 v96, 0x3b124925, v95
    v_rsq_f32 v78, v96
    v_mov_b32 v79, v3
    v_mul_f32 v96, v96, v78
    v_cvt_pk_bf16_f32 v76, v92, v96
    v_lshlrev_b32 v80, 16, v76
    v_sub_f32 v92, v92, v80
    v_and_b32 v80, s74, v76
    v_sub_f32 v96, v96, v80
    v_cvt_pk_bf16_f32 v77, v92, v96
    v_lshrrev_b32 v80, 1, v0
    s_waitcnt vmcnt(8)
    s_mov_b64 exec, 1
    buffer_atomic_add v3, off, s[48:51], s75 sc1
    s_mov_b64 exec, -1
    s_mov_b32 exec_lo, 1
    s_mov_b32 exec_hi, 1
    buffer_store_dwordx4 v[76:79], v80, s[48:51], s70 offen sc1
    s_mov_b64 exec, -1
    s_cmp_ge_u32 s61, 14
    s_cselect_b32 s64, 14, 0
    s_cselect_b32 s65, 1, 0
    s_sub_u32 s64, s61, s64
    s_lshr_b32 s36, s60, 1
    s_mul_i32 s36, s36, 14
    s_add_u32 s36, s36, s64
    s_and_b32 s37, s60, 1
    s_lshl1_add_u32 s37, s37, s65
    s_mul_i32 s64, s37, 401408
    s_mul_i32 s65, s52, 114688
    s_add_u32 s64, s64, s65
    s_lshl_b32 s65, s36, 6
    s_add_u32 s38, s64, s65
    v_mul_u32_u24 v226, 896, v226
    v_add_u32 v224, v224, v226
    v_add_u32 v225, 56320, v224
    s_lshl_b32 s71, s52, 11
    s_cmp_ge_u32 s61, 28
    s_cselect_b32 s38, 2130706432, s38
    s_add_u32 m0, s71, 61440
    s_nop 0
    buffer_load_dwordx4 v224, s[20:23], s38 offen lds
    buffer_load_dwordx4 v225, s[20:23], s38 offen offset:1024 lds
    s_mul_i32 s66, s37, 448
    s_add_u32 s66, s66, 726272
    s_add_u32 s67, s66, 10752
    s_add_u32 s68, s66, 21504
    s_add_u32 s69, s66, 32256
    buffer_load_dwordx4 v[140:143], v234, s[48:51], s66 offen sc1
    buffer_load_dwordx4 v[144:147], v234, s[48:51], s67 offen sc1
    buffer_load_dwordx4 v[148:151], v234, s[48:51], s68 offen sc1
    buffer_load_dwordx4 v[152:155], v234, s[48:51], s69 offen sc1
    s_lshl_b32 s71, s52, 11
    s_waitcnt lgkmcnt(4)
    s_mul_i32 s64, s36, 30720
    s_add_u32 s64, s64, 6291456
    s_mul_i32 s65, s37, 7168
    s_add_u32 m0, s73, 0
    s_add_u32 s76, s82, 512
    s_add_u32 s65, s65, s71
    s_add_u32 s40, s64, s65
    s_lshl_b32 s65, s37, 9
    buffer_load_dwordx4 v220, s[4:7], s76 offen lds
    s_add_u32 s64, s64, s65
    s_add_u32 s64, s64, 28672
    v_add_u32 v9, -17408, v9
    buffer_load_dwordx4 v221, s[4:7], s76 offen offset:1024 lds
    v_add_u32 v10, -17408, v10
    s_cmp_ge_u32 s61, 28
    s_cselect_b32 s40, 2130706432, s40
    s_cselect_b32 s64, 2130706432, s64
    s_cmp_eq_u32 s52, 3
    s_cselect_b32 s41, 2130706432, s40
    s_cselect_b32 s42, s64, 2130706432
    buffer_load_dwordx4 v222, s[4:7], s76 offen offset:2048 lds
    s_load_dwordx2 s[16:17], s[0:1], 24
    s_load_dwordx2 s[24:25], s[0:1], 48
    s_load_dwordx2 s[28:29], s[0:1], 56
    s_load_dwordx2 s[32:33], s[0:1], 64
    buffer_load_dwordx4 v223, s[4:7], s76 offen offset:3072 lds
    s_load_dwordx2 s[44:45], s[0:1], 88
    s_mov_b32 s18, 401408
    s_mov_b32 s19, 0x00020000
    s_mov_b32 s26, 8388608
    s_mov_b32 s27, 0x00020000
    s_mov_b32 s30, 4096
    s_mov_b32 s31, 0x00020000
    s_mov_b32 s34, 802816
    s_mov_b32 s35, 0x00020000
    s_mov_b32 s46, 1835008
    s_mov_b32 s47, 0x00020000
    s_waitcnt lgkmcnt(0)
    s_lshr_b32 s64, s61, 4
    s_lshl1_add_u32 s56, s60, s64
    s_and_b32 s57, s61, 15
    s_cmp_ge_u32 s57, 7
    s_cselect_b32 s64, 1, 0
    s_cselect_b32 s65, 7, 0
    s_lshl1_add_u32 s62, s56, s64
    s_add_u32 m0, s73, 4096
    s_add_u32 s76, s82, 640
    s_sub_u32 s63, s57, s65
    s_and_b32 s64, s60, 1
    s_lshr_b32 s65, s60, 1
    buffer_load_dwordx4 v220, s[4:7], s76 offen lds
    s_and_b32 s59, s61, 3
    s_lshr_b32 s58, s61, 2
    s_mul_i32 s64, s64, 4
    s_add_u32 s59, s64, s59
    buffer_load_dwordx4 v221, s[4:7], s76 offen offset:1024 lds
    s_mul_i32 s65, s65, 8
    s_add_u32 s58, s65, s58
    s_and_b32 s3, s53, 0x9fff0000
    buffer_load_dwordx4 v222, s[4:7], s76 offen offset:2048 lds
    s_or_b32 s3, s3, 0x20000000
    v_and_b32 v15, 1, v0
    v_lshrrev_b32 v13, 2, v0
    buffer_load_dwordx4 v223, s[4:7], s76 offen offset:3072 lds
    v_mul_u32_u24 v13, 480, v13
    v_lshl_add_u32 v13, v15, 4, v13
    v_bfe_u32 v15, v0, 1, 1
    v_lshl_add_u32 v13, v15, 3, v13
    s_and_b32 s64, s52, 1
    s_lshl_b32 s64, s64, 5
    s_add_u32 s64, s64, 128
    v_add_u32 v14, s64, v13
    s_lshr_b32 s64, s52, 1
    s_lshl_b32 s64, s64, 6
    v_add_u32 v13, s64, v13
    v_add_u32 v11, 61440, v1
    s_lshl_b32 s86, s58, 18
    s_lshl_b32 s64, s52, 10
    s_add_u32 s86, s86, s64
    v_mov_b32 v228, v1
    v_add_u32 v229, 3040, v228
    v_add_u32 v230, 6080, v228
    v_add_u32 v231, 9120, v228
    s_waitcnt lgkmcnt(0)
    s_mul_i32 s64, s52, 7680
    v_add_u32 v12, s64, v12
    s_lshl_b32 s70, s88, 9
    s_add_u32 s70, s70, 32768
    s_lshl2_add_u32 s71, s54, s52
    s_lshl_b32 s71, s71, 7
    s_add_u32 s71, s71, 786432
    s_add_u32 s80, s83, s84
    s_lshl_b32 s81, s52, 9
    s_add_u32 s81, s81, 28672
    s_add_u32 s85, s83, s81
    s_mov_b64 exec, 1
    v_mov_b32 v232, 0
    buffer_atomic_add v232, off, s[48:51], s71 sc0 sc1
    s_mov_b64 exec, -1
    s_waitcnt vmcnt(9)
    v_xor_b32 v140, s12, v140
    v_xor_b32 v141, s13, v141
    v_xor_b32 v142, s14, v142
    v_xor_b32 v143, s15, v143
    v_xor_b32 v144, s12, v144
    v_xor_b32 v145, s13, v145
    v_xor_b32 v146, s14, v146
    v_xor_b32 v147, s15, v147
    v_xor_b32 v148, s12, v148
    v_xor_b32 v149, s13, v149
    v_xor_b32 v150, s14, v150
    v_xor_b32 v151, s15, v151
    v_xor_b32 v152, s12, v152
    v_xor_b32 v153, s13, v153
    v_xor_b32 v154, s14, v154
    v_xor_b32_e64 v155, s15, v155
    v_or3_b32 v15, v140, v141, v142
    v_or3_b32 v15, v15, v143, v144
    v_or3_b32 v15, v15, v145, v146
    v_or3_b32 v15, v15, v147, v148
    v_or3_b32 v15, v15, v149, v150
    v_or3_b32 v15, v15, v151, v152
    v_or3_b32 v15, v15, v153, v154
    v_or_b32 v15, v15, v155
    v_and_b32 v15, 0xff, v15
    v_cmp_ne_u32 vcc, 0, v15
    s_nop 0
    s_cbranch_vccnz L_mod2retry
L_mod2ok:
    v_pk_add_f32 v[140:141], v[140:141], v[148:149]
    v_pk_add_f32 v[142:143], v[142:143], v[150:151]
    v_pk_add_f32 v[144:145], v[144:145], v[152:153]
    v_pk_add_f32 v[146:147], v[146:147], v[154:155]
    v_pk_add_f32 v[140:141], v[140:141], v[144:145]
    v_pk_add_f32 v[142:143], v[142:143], v[146:147]
    v_cvt_pk_bf16_f32 v144, v140, v141
    v_cvt_pk_bf16_f32 v145, v142, v143
    v_lshlrev_b32 v140, 16, v144
    v_and_b32 v141, s74, v144
    v_lshlrev_b32 v142, 16, v145
    v_and_b32 v143, s74, v145
    v_add_f32 v140, v140, v238
    v_add_f32 v141, v141, v238
    v_add_f32 v142, v142, v238
    v_add_f32 v143, v143, v238
    v_cvt_pk_bf16_f32 v144, v140, v141
    v_cvt_pk_bf16_f32 v145, v142, v143
    v_lshlrev_b32 v140, 16, v144
    v_and_b32 v141, s74, v144
    v_lshlrev_b32 v142, 16, v145
    v_and_b32 v143, s74, v145
    s_mov_b32 exec_hi, 0
    ds_write_b128 v236, v[140:143]
    s_mov_b32 exec_hi, -1
    ds_write_b64 v237, v[144:145] offset:448
    ds_read_b128 a[0:3], v23 offset:448
    ds_read_b128 a[4:7], v23 offset:480
    ds_read_b128 v[116:119], v233 offset:0
    ds_read_b128 v[120:123], v233 offset:16
    ds_read_b128 a[8:11], v23 offset:512
    ds_read_b128 a[12:15], v23 offset:544
    ds_read_b128 a[16:19], v23 offset:576
    ds_read_b128 v[124:127], v233 offset:64
    ds_read_b128 v[128:131], v233 offset:80
    ds_read_b128 a[20:23], v23 offset:608
    ds_read_b128 a[24:27], v23 offset:640
    s_waitcnt vmcnt(0)
    v_readfirstlane_b32 s79, v232
    s_mul_i32 s78, s53, 12
    s_cmp_lg_u32 s78, s79
    s_cbranch_scc1 L_s1b_wait
L_s1b_ok:
    s_add_u32 m0, s84, 0
    s_add_u32 s76, s80, 0
    buffer_load_dwordx4 v1, s[48:51], s76 offen sc1 lds
    buffer_load_dwordx4 v1, s[48:51], s76 offen offset:1024 sc1 lds
    buffer_load_dwordx4 v1, s[48:51], s76 offen offset:2048 sc1 lds
    buffer_load_dwordx4 v1, s[48:51], s76 offen offset:3072 sc1 lds
    s_add_u32 m0, s84, 4096
    s_add_u32 s76, s80, 4096
    buffer_load_dwordx4 v1, s[48:51], s76 offen sc1 lds
    buffer_load_dwordx4 v1, s[48:51], s76 offen offset:1024 sc1 lds
    buffer_load_dwordx4 v1, s[48:51], s76 offen offset:2048 sc1 lds
    s_add_u32 m0, s81, 0
    s_add_u32 s76, s85, 0
    s_mov_b32 exec_hi, 0
    buffer_load_dwordx4 v1, s[48:51], s76 offen sc1 lds
    s_mov_b32 exec_hi, -1
    s_barrier
    ds_read_b128 a[160:163], v4 offset:8192
    ds_read_b128 a[164:167], v5 offset:8192
    ds_read_b128 a[168:171], v6 offset:8192
    ds_read_b128 a[172:175], v7 offset:8192
    ds_read_b128 a[176:179], v4 offset:12288
    ds_read_b128 a[180:183], v5 offset:12288
    ds_read_b128 a[184:187], v6 offset:12288
    ds_read_b128 a[188:191], v7 offset:12288
    ds_read_b128 a[192:195], v4 offset:0
    ds_read_b128 a[196:199], v5 offset:0
    ds_read_b128 a[200:203], v6 offset:0
    ds_read_b128 a[204:207], v7 offset:0
    ds_read_b128 a[208:211], v4 offset:4096
    ds_read_b128 a[212:215], v5 offset:4096
    ds_read_b128 a[216:219], v6 offset:4096
    ds_read_b128 a[220:223], v7 offset:4096
    ds_read_b64_tr_b16 v[32:33], v10 offset:0
    ds_read_b64_tr_b16 v[34:35], v10 offset:256
    ds_read_b64_tr_b16 v[36:37], v10 offset:1024
    ds_read_b64_tr_b16 v[38:39], v10 offset:1280
    ds_read_b64_tr_b16 a[64:65], v9 offset:0
    ds_read_b64_tr_b16 a[66:67], v9 offset:256
    ds_read_b64_tr_b16 a[68:69], v9 offset:1024
    ds_read_b64_tr_b16 a[70:71], v9 offset:1280
    ds_read_b64_tr_b16 a[72:73], v9 offset:2048
    ds_read_b64_tr_b16 a[74:75], v9 offset:2304
    ds_read_b64_tr_b16 a[76:77], v9 offset:3072
    s_waitcnt lgkmcnt(15)
    ds_read_b64_tr_b16 a[78:79], v9 offset:3328
    ds_read_b64_tr_b16 a[80:81], v9 offset:4096
    ds_read_b64_tr_b16 a[82:83], v9 offset:4352
    ds_read_b64_tr_b16 a[84:85], v9 offset:5120
    ds_read_b64_tr_b16 a[86:87], v9 offset:5376
    s_add_u32 m0, s73, 8192
    s_add_u32 s76, s82, 768
    ds_read_b64_tr_b16 a[88:89], v9 offset:6144
    ds_read_b64_tr_b16 a[90:91], v9 offset:6400
    s_waitcnt lgkmcnt(15)
    v_lshlrev_b32 v60, 16, v32
    v_and_b32 v61, s74, v32
    v_lshlrev_b32 v62, 16, v33
    v_and_b32 v63, s74, v33
    buffer_load_dwordx4 v220, s[4:7], s76 offen lds
    v_lshlrev_b32 v64, 16, v34
    v_and_b32 v65, s74, v34
    v_lshlrev_b32 v66, 16, v35
    v_and_b32 v67, s74, v35
    v_lshlrev_b32 v68, 16, v36
    buffer_load_dwordx4 v221, s[4:7], s76 offen offset:1024 lds
    v_and_b32 v69, s74, v36
    v_lshlrev_b32 v70, 16, v37
    v_and_b32 v71, s74, v37
    s_waitcnt lgkmcnt(14)
    v_lshlrev_b32 v72, 16, v38
    v_and_b32 v73, s74, v38
    v_lshlrev_b32 v74, 16, v39
    buffer_load_dwordx4 v222, s[4:7], s76 offen offset:2048 lds
    v_and_b32 v75, s74, v39
    s_waitcnt lgkmcnt(12)
    v_mfma_f32_32x32x16_bf16 v[204:219], a[0:3], a[64:67], 0
    buffer_load_dwordx4 v223, s[4:7], s76 offen offset:3072 lds
    v_mul_f32 v60, v60, v116
    v_mul_f32 v61, v61, v117
    v_cvt_pk_bf16_f32 v244, v60, v61
    s_waitcnt lgkmcnt(10)
    v_mfma_f32_32x32x16_bf16 v[204:219], a[4:7], a[68:71], v[204:219]
    v_mul_f32 v62, v62, v118
    v_mul_f32 v63, v63, v119
    v_cvt_pk_bf16_f32 v245, v62, v63
    s_waitcnt lgkmcnt(8)
    v_mfma_f32_32x32x16_bf16 v[204:219], a[8:11], a[72:75], v[204:219]
    v_mul_f32 v64, v64, v120
    v_mul_f32 v65, v65, v121
    s_waitcnt lgkmcnt(6)
    v_mfma_f32_32x32x16_bf16 v[204:219], a[12:15], a[76:79], v[204:219]
    v_cvt_pk_bf16_f32 v246, v64, v65
    v_mul_f32 v66, v66, v122
    v_mul_f32 v67, v67, v123
    s_add_u32 m0, s84, 30720
    s_add_u32 s76, s80, 30720
    s_waitcnt lgkmcnt(4)
    v_mfma_f32_32x32x16_bf16 v[204:219], a[16:19], a[80:83], v[204:219]
    v_cvt_pk_bf16_f32 v247, v66, v67
    buffer_store_dwordx4 v[244:247], v1, s[48:51], s40 offen sc1
    v_mul_f32 v68, v68, v124
    s_waitcnt lgkmcnt(2)
    v_mfma_f32_32x32x16_bf16 v[204:219], a[20:23], a[84:87], v[204:219]
    buffer_load_dwordx4 v1, s[48:51], s76 offen sc1 lds
    v_mul_f32 v69, v69, v125
    v_cvt_pk_bf16_f32 v248, v68, v69
    s_waitcnt lgkmcnt(0)
    v_mfma_f32_32x32x16_bf16 v[204:219], a[24:27], a[88:91], v[204:219]
    buffer_load_dwordx4 v1, s[48:51], s76 offen offset:1024 sc1 lds
    v_mul_f32 v70, v70, v126
    v_mul_f32 v71, v71, v127
    v_cvt_pk_bf16_f32 v249, v70, v71
    v_mul_f32 v72, v72, v128
    v_mul_f32 v73, v73, v129
    v_cvt_pk_bf16_f32 v250, v72, v73
    v_mul_f32 v74, v74, v130
    v_mul_f32 v75, v75, v131
    v_cvt_pk_bf16_f32 v251, v74, v75
    buffer_load_dwordx4 v1, s[48:51], s76 offen offset:2048 sc1 lds
    buffer_store_dwordx4 v[248:251], v1, s[48:51], s41 offen offset:1024 sc1
    v_cvt_pk_bf16_f32 v116, v204, v205
    v_lshlrev_b32 v60, 16, v116
    v_sub_f32 v204, v204, v60
    v_and_b32 v60, s74, v116
    buffer_load_dwordx4 v1, s[48:51], s76 offen offset:3072 sc1 lds
    v_sub_f32 v205, v205, v60
    v_cvt_pk_bf16_f32 v118, v204, v205
    v_mov_b32 v117, v116
    v_mov_b32 v119, 0
    s_mov_b32 exec_hi, 0
    buffer_store_dwordx4 v[116:119], v1, s[48:51], s42 offen sc1
    s_mov_b32 exec_hi, -1
    s_waitcnt vmcnt(11)
    s_waitcnt lgkmcnt(0)
    s_barrier
    ds_read_b128 a[32:35], v1 offset:0
    ds_read_b128 a[36:39], v1 offset:1024
    ds_read_b128 a[40:43], v1 offset:2048
    ds_read_b128 a[44:47], v1 offset:3072
    ds_read_b128 a[48:51], v1 offset:4096
    s_waitcnt lgkmcnt(4)
    v_mfma_f32_32x32x16_bf16 v[172:187], a[32:35], a[128:131], 0
    ds_read_b128 a[52:55], v1 offset:5120
    v_lshlrev_b32 v232, 7, v0
    s_add_u32 m0, s84, 34816
    s_add_u32 s76, s80, 34816
    v_bfe_u32 v15, v0, 3, 2
    v_lshlrev_b32 v233, 12, v15
    s_waitcnt lgkmcnt(4)
    v_mfma_f32_32x32x16_bf16 v[172:187], a[36:39], a[132:135], v[172:187]
    buffer_load_dwordx4 v1, s[48:51], s76 offen sc1 lds
    ds_read_b128 a[56:59], v1 offset:6144
    v_and_b32 v15, 7, v0
    v_lshl_add_u32 v233, v15, 7, v233
    s_waitcnt lgkmcnt(3)
    v_mfma_f32_32x32x16_bf16 v[172:187], a[40:43], a[136:139], v[172:187]
    buffer_load_dwordx4 v1, s[48:51], s76 offen offset:1024 sc1 lds
    ds_read_b128 a[60:63], v1 offset:7168
    v_bfe_u32 v124, v0, 3, 2
    v_and_b32 v125, 3, v0
    v_mfma_f32_32x32x16_bf16 v[172:187], a[44:47], a[140:143], v[172:187]
    buffer_load_dwordx4 v1, s[48:51], s76 offen offset:2048 sc1 lds
    ds_read_b128 a[32:35], v1 offset:8192
    v_lshl_add_u32 v124, v124, 2, v125
    v_and_b32 v125, 7, v124
    s_add_u32 m0, s81, 30720
    s_add_u32 s76, s85, 30720
    s_waitcnt lgkmcnt(3)
    v_mfma_f32_32x32x16_bf16 v[172:187], a[48:51], a[144:147], v[172:187]
    ds_read_b128 a[36:39], v1 offset:9216
    v_cmp_ne_u32 vcc, 7, v125
    v_lshrrev_b32 v125, 3, v124
    s_mov_b32 exec_hi, 0
    buffer_load_dwordx4 v1, s[48:51], s76 offen sc1 lds
    s_mov_b32 exec_hi, -1
    v_mfma_f32_32x32x16_bf16 v[172:187], a[52:55], a[148:151], v[172:187]
    ds_read_b128 a[40:43], v1 offset:10240
    v_sub_u32 v124, v124, v125
    v_bfe_u32 v125, v0, 2, 1
    s_waitcnt lgkmcnt(3)
    v_mfma_f32_32x32x16_bf16 v[172:187], a[56:59], a[152:155], v[172:187]
    buffer_load_dwordx4 v[16:19], v235, s[48:51], s70 offen sc1
    ds_read_b128 a[44:47], v1 offset:11264
    v_mul_u32_u24 v125, 14, v125
    v_add_u32 v124, v124, v125
    v_lshrrev_b32_e64 v125, 5, v0
    v_mfma_f32_32x32x16_bf16 v[172:187], a[60:63], a[156:159], v[172:187]
    ds_read_b128 a[48:51], v1 offset:12288
    v_mul_u32_u24 v125, 224, v125
    s_add_u32 m0, s84, 61440
    s_add_u32 s76, s80, 61440
    v_lshl_add_u32 v124, v124, 1, v125
    s_waitcnt lgkmcnt(3)
    v_mfma_f32_32x32x16_bf16 v[172:187], a[32:35], a[160:163], v[172:187]
    buffer_load_dwordx4 v1, s[48:51], s76 offen sc1 lds
    ds_read_b128 a[52:55], v1 offset:13312
    v_add_u32 v124, 157696, v124
    ds_read_u16 v126, v124 offset:0
    v_mfma_f32_32x32x16_bf16 v[172:187], a[36:39], a[164:167], v[172:187]
    buffer_load_dwordx4 v1, s[48:51], s76 offen offset:1024 sc1 lds
    ds_read_b128 a[56:59], v1 offset:14336
    ds_read_u16 v127, v124 offset:56
    ds_read_u16 v128, v124 offset:112
    ds_read_u16 v129, v124 offset:168
    s_waitcnt lgkmcnt(7)
    v_mfma_f32_32x32x16_bf16 v[172:187], a[40:43], a[168:171], v[172:187]
    buffer_load_dwordx4 v1, s[48:51], s76 offen offset:2048 sc1 lds
    ds_read_b128 a[60:63], v1 offset:15360
    ds_read_u16 v130, v124 offset:448
    ds_read_u16 v131, v124 offset:504
    v_mfma_f32_32x32x16_bf16 v[172:187], a[44:47], a[172:175], v[172:187]
    buffer_load_dwordx4 v1, s[48:51], s76 offen offset:3072 sc1 lds
    ds_read_b128 a[32:35], v1 offset:16384
    ds_read_u16 v132, v124 offset:560
    ds_read_u16 v133, v124 offset:616
    s_waitcnt lgkmcnt(11)
    v_mfma_f32_32x32x16_bf16 v[172:187], a[48:51], a[176:179], v[172:187]
    ds_read_b128 a[36:39], v1 offset:17408
    ds_read_u16 v134, v124 offset:896
    s_add_u32 m0, s84, 65536
    s_add_u32 s76, s80, 65536
    ds_read_u16 v135, v124 offset:952
    ds_read_u16 v136, v124 offset:1008
    v_mfma_f32_32x32x16_bf16 v[172:187], a[52:55], a[180:183], v[172:187]
    buffer_load_dwordx4 v1, s[48:51], s76 offen sc1 lds
    ds_read_b128 a[40:43], v1 offset:18432
    ds_read_u16 v137, v124 offset:1064
    ds_read_u16 v138, v124 offset:1344
    s_waitcnt lgkmcnt(12)
    v_mfma_f32_32x32x16_bf16 v[172:187], a[56:59], a[184:187], v[172:187]
    buffer_load_dwordx4 v1, s[48:51], s76 offen offset:1024 sc1 lds
    ds_read_b128 a[44:47], v1 offset:19456
    ds_read_u16 v139, v124 offset:1400
    ds_read_u16 v140, v124 offset:1456
    v_mfma_f32_32x32x16_bf16 v[172:187], a[60:63], a[188:191], v[172:187]
    buffer_load_dwordx4 v1, s[48:51], s76 offen offset:2048 sc1 lds
    ds_read_b128 a[48:51], v1 offset:20480
    ds_read_u16 v141, v124 offset:1512
    s_waitcnt lgkmcnt(0)
    v_lshl_or_b32 v24, v127, 16, v126
    v_mfma_f32_32x32x16_bf16 v[172:187], a[32:35], a[192:195], v[172:187]
    ds_read_b128 a[52:55], v1 offset:21504
    s_add_u32 m0, s81, 61440
    s_add_u32 s76, s85, 61440
    v_cndmask_b32 v24, 0, v24, vcc
    v_lshl_or_b32 v25, v129, 16, v128
    v_mfma_f32_32x32x16_bf16 v[172:187], a[36:39], a[196:199], v[172:187]
    ds_read_b128 a[56:59], v1 offset:22528
    s_mov_b32 exec_hi, 0
    buffer_load_dwordx4 v1, s[48:51], s76 offen sc1 lds
    s_mov_b32 exec_hi, -1
    v_cndmask_b32 v25, 0, v25, vcc
    v_lshl_or_b32 v26, v131, 16, v130
    v_mfma_f32_32x32x16_bf16 v[172:187], a[40:43], a[200:203], v[172:187]
    ds_read_b128 a[60:63], v1 offset:23552
    v_cndmask_b32 v26, 0, v26, vcc
    v_lshl_or_b32 v27, v133, 16, v132
    s_lshl2_add_u32 s71, s2, s52
    v_mfma_f32_32x32x16_bf16 v[172:187], a[44:47], a[204:207], v[172:187]
    ds_read_b128 a[32:35], v1 offset:24576
    s_branch L_page1
.p2align 12
L_stub1:
    s_branch L_stub5
L_page1:
    s_waitcnt vmcnt(20)
    ds_read_b128 a[224:227], v4 offset:8192
    ds_read_b128 a[228:231], v5 offset:8192
    v_cndmask_b32 v27, 0, v27, vcc
    v_lshl_or_b32 v28, v135, 16, v134
    s_mul_i32 s77, s71, 512
    s_waitcnt lgkmcnt(5)
    v_mfma_f32_32x32x16_bf16 v[172:187], a[48:51], a[208:211], v[172:187]
    ds_read_b128 a[36:39], v1 offset:25600
    ds_read_b128 a[232:235], v6 offset:8192
    ds_read_b128 a[236:239], v7 offset:8192
    v_cndmask_b32 v28, 0, v28, vcc
    v_lshl_or_b32 v29, v137, 16, v136
    s_mov_b64 exec, 0xf
    buffer_load_dword v240, v232, s[16:19], s77 offen
    s_mov_b64 exec, -1
    v_mfma_f32_32x32x16_bf16 v[172:187], a[52:55], a[212:215], v[172:187]
    ds_read_b128 a[40:43], v1 offset:26624
    v_cndmask_b32 v29, 0, v29, vcc
    v_lshl_or_b32 v30, v139, 16, v138
    s_lshl_b32 s39, s59, 13
    v_cndmask_b32 v30, 0, v30, vcc
    s_waitcnt lgkmcnt(7)
    v_mfma_f32_32x32x16_bf16 v[172:187], a[56:59], a[216:219], v[172:187]
    ds_read_b128 a[44:47], v1 offset:27648
    v_lshl_or_b32 v31, v141, 16, v140
    s_add_u32 s39, s39, s86
    s_lshl_b32 s38, s52, 16
    s_add_u32 s39, s39, s38
    v_cndmask_b32 v31, 0, v31, vcc
    v_mfma_f32_32x32x16_bf16 v[172:187], a[60:63], a[220:223], v[172:187]
    ds_read_b128 a[48:51], v1 offset:28672
    s_mov_b32 exec_lo, 0
    v_mov_b32 v30, 0
    v_mov_b32 v31, 0
    s_mov_b32 exec_lo, -1
    s_waitcnt vmcnt(9)
    v_xor_b32 v19, s53, v19
    v_cmp_ne_u32 vcc, 0, v19
    s_waitcnt lgkmcnt(5)
    v_mfma_f32_32x32x16_bf16 v[172:187], a[32:35], a[224:227], v[172:187]
    ds_read_b128 a[52:55], v1 offset:29696
    s_cbranch_vccnz L_lnretry
L_lnok:
    v_mov_b32 v20, v18
    v_mul_f32 v21, 0x3fb8aa3b, v18
    v_mov_b32 v18, v16
    v_mfma_f32_32x32x16_bf16 v[172:187], a[36:39], a[228:231], v[172:187]
    v_lshrrev_b32 v224, 3, v0
    v_and_b32 v225, 6, v224
    v_mul_u32_u24 v224, 896, v224
    s_waitcnt lgkmcnt(2)
    v_mfma_f32_32x32x16_bf16 v[172:187], a[40:43], a[232:235], v[172:187]
    v_xor_b32 v225, v225, v0
    v_and_b32_e64 v225, 7, v225
    v_lshl_add_u32 v224, v225, 4, v224
    v_mfma_f32_32x32x16_bf16 v[172:187], a[44:47], a[236:239], v[172:187]
    v_add_u32 v225, 6144, v224
    v_add_u32 v226, 12288, v224
    v_add_u32 v227, 18432, v224
    s_mul_i32 s83, s52, 100352
    s_lshl_b32 s66, s63, 7
    s_waitcnt lgkmcnt(0)
    v_mfma_f32_32x32x16_bf16 v[172:187], a[48:51], v[16:19], v[172:187]
    s_add_u32 s83, s83, s66
    s_mul_i32 s89, s52, 14336
    s_lshl_b32 s64, s54, 4
    s_add_u32 s64, s64, s55
    s_lshl2_add_u32 s64, s64, s52
    s_lshl_b32 s64, s64, 10
    v_mfma_f32_32x32x16_bf16 v[172:187], a[52:55], v[16:19], v[172:187]
    s_add_u32 s64, s64, 1048576
    s_lshl2_add_u32 s75, s54, s52
    s_lshl_b32 s75, s75, 7
    s_add_u32 s84, s75, 856064
    s_waitcnt lgkmcnt(0)
    s_barrier
    ds_read_b128 a[32:35], v1 offset:30720
    ds_read_b128 a[36:39], v1 offset:31744
    ds_read_b128 a[40:43], v1 offset:32768
    ds_read_b128 a[44:47], v1 offset:33792
    ds_read_b128 a[48:51], v1 offset:34816
    s_waitcnt lgkmcnt(4)
    v_mfma_f32_32x32x16_bf16 v[188:203], a[32:35], a[128:131], 0
    ds_read_b128 a[52:55], v1 offset:35840
    v_cvt_pk_bf16_f32 v60, v172, v173
    v_cvt_pk_bf16_f32 v61, v174, v175
    v_cvt_pk_bf16_f32 v62, v176, v177
    v_cvt_pk_bf16_f32 v63, v178, v179
    v_cvt_pk_bf16_f32 v64, v180, v181
    s_waitcnt lgkmcnt(4)
    v_mfma_f32_32x32x16_bf16 v[188:203], a[36:39], a[132:135], v[188:203]
    ds_read_b128 a[56:59], v1 offset:36864
    v_cvt_pk_bf16_f32 v65, v182, v183
    v_cvt_pk_bf16_f32 v66, v184, v185
    v_cvt_pk_bf16_f32 v67, v186, v187
    v_mfma_f32_32x32x16_bf16 v[204:219], v[24:27], v[60:63], 0
    s_waitcnt lgkmcnt(3)
    v_mfma_f32_32x32x16_bf16 v[188:203], a[40:43], a[136:139], v[188:203]
    ds_read_b128 a[60:63], v1 offset:37888
    v_mfma_f32_32x32x16_bf16 v[204:219], v[28:31], v[64:67], v[204:219]
    v_and_b32 v243, 15, v0
    v_mul_u32_u24 v243, 896, v243
    v_bfe_u32 v242, v0, 4, 1
    v_mfma_f32_32x32x16_bf16 v[188:203], a[44:47], a[140:143], v[188:203]
    ds_read_b128 a[32:35], v1 offset:38912
    v_lshl_add_u32 v243, v242, 5, v243
    v_lshrrev_b32 v242, 5, v0
    v_lshl_add_u32 v243, v242, 4, v243
    s_lshl2_add_u32 s82, s62, s52
    s_mul_i32 s82, s82, 14336
    s_lshl_b32 s79, s63, 7
    s_add_u32 s82, s82, s79
    s_waitcnt lgkmcnt(3)
    v_mfma_f32_32x32x16_bf16 v[188:203], a[48:51], a[144:147], v[188:203]
    ds_read_b128 a[36:39], v1 offset:39936
    v_max3_f32 v68, v204, v205, v206
    v_min3_f32 v69, v204, v205, v206
    v_max3_f32 v68, v68, v207, v208
    v_min3_f32 v69, v69, v207, v208
    v_mfma_f32_32x32x16_bf16 v[188:203], a[52:55], a[148:151], v[188:203]
    ds_read_b128 a[40:43], v1 offset:40960
    v_max3_f32 v68, v68, v209, v210
    v_min3_f32 v69, v69, v209, v210
    v_max3_f32 v68, v68, v212, v213
    v_min3_f32 v69, v69, v212, v213
    s_waitcnt lgkmcnt(3)
    v_mfma_f32_32x32x16_bf16 v[188:203], a[56:59], a[152:155], v[188:203]
    ds_read_b128 a[44:47], v1 offset:41984
    v_max3_f32 v68, v68, v214, v215
    v_min3_f32 v69, v69, v214, v215
    v_max3_f32 v68, v68, v216, v217
    v_min3_f32 v69, v69, v216, v217
    v_max_f32 v68, v68, v218
    v_mfma_f32_32x32x16_bf16 v[188:203], a[60:63], a[156:159], v[188:203]
    ds_read_b128 a[48:51], v1 offset:43008
    v_max_f32 v69, -v69, -v218
    s_nop 1
    v_permlane32_swap_b32 v68, v69
    v_max_f32 v68, v68, v69
    v_mul_f32 v68, v68, -v21
    s_waitcnt lgkmcnt(3)
    v_mfma_f32_32x32x16_bf16 v[188:203], a[32:35], a[160:163], v[188:203]
    ds_read_b128 a[52:55], v1 offset:44032
    v_mov_b32 v69, v68
    s_nop 1
    v_permlane32_swap_b32 v68, v69
    v_fma_f32 v72, v204, v21, v68
    v_fma_f32 v88, v204, -v21, v69
    v_mfma_f32_32x32x16_bf16 v[188:203], a[36:39], a[164:167], v[188:203]
    buffer_load_dwordx4 v[248:251], v243, s[4:7], s82 offen
    ds_read_b128 a[56:59], v1 offset:45056
    v_exp_f32 v72, v72
    v_exp_f32 v88, v88
    v_fma_f32 v73, v205, v21, v68
    s_waitcnt lgkmcnt(3)
    v_mfma_f32_32x32x16_bf16 v[188:203], a[40:43], a[168:171], v[188:203]
    buffer_load_dwordx4 v[252:255], v243, s[4:7], s82 offen offset:64
    ds_read_b128 a[60:63], v1 offset:46080
    v_fma_f32 v89, v205, -v21, v69
    v_exp_f32 v73, v73
    v_exp_f32 v89, v89
    v_fma_f32 v74, v206, v21, v68
    v_mfma_f32_32x32x16_bf16 v[188:203], a[44:47], a[172:175], v[188:203]
    ds_read_b128 a[32:35], v1 offset:47104
    v_fma_f32 v90, v206, -v21, v69
    v_exp_f32 v74, v74
    v_exp_f32 v90, v90
    v_add_f32 v60, v72, v73
    s_waitcnt lgkmcnt(3)
    v_mfma_f32_32x32x16_bf16 v[188:203], a[48:51], a[176:179], v[188:203]
    ds_read_b128 a[36:39], v1 offset:48128
    v_add_f32_e64 v61, v88, v89
    v_fma_f32 v75, v207, v21, v68
    s_mul_i32 s73, s52, 16896
    s_add_u32 s73, s73, 92160
    v_fma_f32 v91, v207, -v21, v69
    v_mfma_f32_32x32x16_bf16 v[188:203], a[52:55], a[180:183], v[188:203]
    ds_read_b128 a[40:43], v1 offset:49152
    v_exp_f32 v75, v75
    v_exp_f32 v91, v91
    v_add_f32 v60, v60, v74
    v_add_f32 v61, v61, v90
    v_fma_f32 v76, v208, v21, v68
    s_waitcnt lgkmcnt(3)
    v_mfma_f32_32x32x16_bf16 v[188:203], a[56:59], a[184:187], v[188:203]
    ds_read_b128 a[44:47], v1 offset:50176
    s_add_u32 s77, s52, 1
    s_and_b32 s77, s77, 3
    v_fma_f32 v92, v208, -v21, v69
    v_exp_f32 v76, v76
    v_exp_f32 v92, v92
    v_mfma_f32_32x32x16_bf16 v[188:203], a[60:63], a[188:191], v[188:203]
    ds_read_b128 a[48:51], v1 offset:51200
    v_add_f32 v60, v60, v75
    v_add_f32 v61, v61, v91
    v_fma_f32 v77, v209, v21, v68
    v_fma_f32 v93, v209, -v21, v69
    s_waitcnt lgkmcnt(3)
    v_mfma_f32_32x32x16_bf16 v[188:203], a[32:35], a[192:195], v[188:203]
    ds_read_b128 a[52:55], v1 offset:52224
    s_lshl_b32 s77, s77, 16
    s_add_u32 s77, s77, s86
    v_exp_f32 v77, v77
    v_exp_f32 v93, v93
    v_add_f32 v60, v60, v76
    v_add_f32 v61, v61, v92
    v_mfma_f32_32x32x16_bf16 v[188:203], a[36:39], a[196:199], v[188:203]
    ds_read_b128 a[56:59], v1 offset:53248
    v_fma_f32 v78, v210, v21, v68
    v_fma_f32 v94, v210, -v21, v69
    s_add_u32 s79, s59, 0
    s_and_b32 s79, s79, 3
    s_mul_i32 s76, s79, 4224
    s_add_u32 m0, s73, s76
    s_lshl_b32 s79, s79, 14
    s_add_u32 s76, s77, s79
    v_exp_f32 v78, v78
    s_waitcnt lgkmcnt(3)
    v_mfma_f32_32x32x16_bf16 v[188:203], a[40:43], a[200:203], v[188:203]
    ds_read_b128 a[60:63], v1 offset:54272
    v_exp_f32 v94, v94
    v_add_f32 v60, v60, v77
    v_add_f32 v61, v61, v93
    v_fma_f32 v80, v212, v21, v68
    v_mfma_f32_32x32x16_bf16 v[188:203], a[44:47], a[204:207], v[188:203]
    buffer_load_dwordx4 v228, s[24:27], s76 offen lds
    ds_read_b128 a[32:35], v1 offset:55296
    v_fma_f32 v96, v212, -v21, v69
    v_exp_f32 v80, v80
    v_exp_f32 v96, v96
    s_waitcnt lgkmcnt(3)
    v_mfma_f32_32x32x16_bf16 v[188:203], a[48:51], a[208:211], v[188:203]
    ds_read_b128 a[36:39], v1 offset:56320
    v_add_f32 v60, v60, v78
    v_add_f32 v61, v61, v94
    v_fma_f32 v81, v213, v21, v68
    v_fma_f32 v97, v213, -v21, v69
    v_exp_f32 v81, v81
    v_mfma_f32_32x32x16_bf16 v[188:203], a[52:55], a[212:215], v[188:203]
    buffer_load_dwordx4 v229, s[24:27], s76 offen offset:1056 lds
    ds_read_b128 a[40:43], v1 offset:57344
    v_exp_f32 v97, v97
    v_add_f32 v60, v60, v80
    v_add_f32 v61, v61, v96
    s_waitcnt lgkmcnt(3)
    v_mfma_f32_32x32x16_bf16 v[188:203], a[56:59], a[216:219], v[188:203]
    ds_read_b128 a[44:47], v1 offset:58368
    v_fma_f32 v82, v214, v21, v68
    v_fma_f32 v98, v214, -v21, v69
    v_exp_f32 v82, v82
    v_exp_f32 v98, v98
    v_mfma_f32_32x32x16_bf16 v[188:203], a[60:63], a[220:223], v[188:203]
    buffer_load_dwordx4 v230, s[24:27], s76 offen offset:2112 lds
    ds_read_b128 a[48:51], v1 offset:59392
    v_add_f32 v60, v60, v81
    v_add_f32 v61, v61, v97
    v_fma_f32 v83, v215, v21, v68
    v_fma_f32 v99, v215, -v21, v69
    s_waitcnt lgkmcnt(3)
    v_mfma_f32_32x32x16_bf16 v[188:203], a[32:35], a[224:227], v[188:203]
    buffer_load_dwordx4 v231, s[24:27], s76 offen offset:3168 lds
    ds_read_b128 a[52:55], v1 offset:60416
    v_exp_f32 v83, v83
    v_exp_f32 v99, v99
    v_add_f32 v60, v60, v82
    v_mfma_f32_32x32x16_bf16 v[188:203], a[36:39], a[228:231], v[188:203]
    v_add_f32 v61, v61, v98
    v_fma_f32 v84, v216, v21, v68
    v_fma_f32 v100, v216, -v21, v69
    v_exp_f32 v84, v84
    s_waitcnt lgkmcnt(2)
    v_mfma_f32_32x32x16_bf16 v[188:203], a[40:43], a[232:235], v[188:203]
    v_exp_f32 v100, v100
    v_add_f32 v60, v60, v83
    s_mov_b64 exec, 0xff
    buffer_load_dword v235, v233, s[24:27], s39 offen
    s_mov_b64 exec, -1
    v_add_f32 v61, v61, v99
    v_fma_f32 v85, v217, v21, v68
    v_mfma_f32_32x32x16_bf16 v[188:203], a[44:47], a[236:239], v[188:203]
    v_fma_f32 v101, v217, -v21, v69
    v_exp_f32 v85, v85
    v_exp_f32 v101, v101
    v_add_f32 v60, v60, v84
    s_waitcnt lgkmcnt(0)
    v_mfma_f32_32x32x16_bf16 v[188:203], a[48:51], v[16:19], v[188:203]
    v_add_f32 v61, v61, v100
    s_mov_b64 exec, 0xff00
    buffer_load_dword v236, v233, s[24:27], s39 offen
    s_mov_b64 exec, -1
    v_fma_f32 v86, v218, v21, v68
    v_fma_f32 v102, v218, -v21, v69
    v_mfma_f32_32x32x16_bf16 v[188:203], a[52:55], v[16:19], v[188:203]
    v_exp_f32 v86, v86
    v_exp_f32 v102, v102
    v_add_f32 v60, v60, v85
    v_add_f32 v61, v61, v101
    v_add_f32 v60, v60, v86
    v_add_f32 v61, v61, v102
    s_nop 1
    v_permlane32_swap_b32 v60, v61
    v_add_f32 v60, v60, v61
    v_rcp_f32 v60, v60
    s_nop 0
    v_mul_f32 v60, v60, v20
    v_mov_b32 v61, v60
    s_nop 1
    v_permlane32_swap_b32 v60, v61
    v_pk_mul_f32 v[72:73], v[72:73], v[60:61] op_sel:[0,0] op_sel_hi:[1,0]
    v_cvt_pk_bf16_f32 v32, v72, v73
    v_pk_mul_f32 v[74:75], v[74:75], v[60:61] op_sel:[0,0] op_sel_hi:[1,0]
    v_cvt_pk_bf16_f32 v33, v74, v75
    v_cvt_pk_bf16_f32 v48, v188, v189
    v_cvt_pk_bf16_f32 v49, v190, v191
    v_cvt_pk_bf16_f32 v50, v192, v193
    v_cvt_pk_bf16_f32 v51, v194, v195
    ds_write_b128 v12, v[48:51] offset:128
    v_cvt_pk_bf16_f32 v52, v196, v197
    v_cvt_pk_bf16_f32 v53, v198, v199
    v_cvt_pk_bf16_f32 v54, v200, v201
    v_cvt_pk_bf16_f32 v55, v202, v203
    s_mov_b32 exec_lo, 0
    v_lshrrev_b32 v54, 16, v16
    s_mov_b32 exec_lo, -1
    ds_write_b128 v12, v[52:55] offset:160
    v_pk_mul_f32 v[76:77], v[76:77], v[60:61] op_sel:[0,0] op_sel_hi:[1,0]
    v_cvt_pk_bf16_f32 v36, v76, v77
    v_mul_f32 v78, v78, v60
    v_cvt_pk_bf16_f32 v37, v78, 0
    v_pk_mul_f32 v[80:81], v[80:81], v[60:61] op_sel:[0,0] op_sel_hi:[1,0]
    v_cvt_pk_bf16_f32 v34, v80, v81
    v_pk_mul_f32 v[82:83], v[82:83], v[60:61] op_sel:[0,0] op_sel_hi:[1,0]
    v_cvt_pk_bf16_f32 v35, v82, v83
    ds_write_b128 v12, v[32:35] offset:0
    v_pk_mul_f32 v[84:85], v[84:85], v[60:61] op_sel:[0,0] op_sel_hi:[1,0]
    v_cvt_pk_bf16_f32 v38, v84, v85
    v_mul_f32_e64 v86, v86, v60
    v_cvt_pk_bf16_f32 v39, v86, 0
    ds_write_b128 v12, v[36:39] offset:32
    v_pk_mul_f32 v[88:89], v[88:89], v[60:61] op_sel:[0,1] op_sel_hi:[1,1]
    v_cvt_pk_bf16_f32 v40, v88, v89
    v_pk_mul_f32 v[90:91], v[90:91], v[60:61] op_sel:[0,1] op_sel_hi:[1,1]
    v_cvt_pk_bf16_f32 v41, v90, v91
    v_pk_mul_f32 v[92:93], v[92:93], v[60:61] op_sel:[0,1] op_sel_hi:[1,1]
    v_cvt_pk_bf16_f32 v44, v92, v93
    v_mul_f32_e64 v94, v94, v61
    v_cvt_pk_bf16_f32 v45, v94, 0
    v_pk_mul_f32 v[96:97], v[96:97], v[60:61] op_sel:[0,1] op_sel_hi:[1,1]
    v_cvt_pk_bf16_f32 v42, v96, v97
    v_pk_mul_f32 v[98:99], v[98:99], v[60:61] op_sel:[0,1] op_sel_hi:[1,1]
    v_cvt_pk_bf16_f32 v43, v98, v99
    ds_write_b128 v12, v[40:43] offset:64
    v_pk_mul_f32 v[100:101], v[100:101], v[60:61] op_sel:[0,1] op_sel_hi:[1,1]
    v_cvt_pk_bf16_f32 v46, v100, v101
    v_mul_f32 v102, v102, v61
    v_cvt_pk_bf16_f32 v47, v102, 0
    ds_write_b128 v12, v[44:47] offset:96
    s_waitcnt vmcnt(9)
    s_waitcnt lgkmcnt(0)
    s_barrier
    ds_read_b64_tr_b16 v[68:69], v14 offset:0
    ds_read_b64_tr_b16 v[72:73], v13 offset:0
    ds_read_b64_tr_b16 v[76:77], v13 offset:32
    ds_read_b64_tr_b16 v[70:71], v14 offset:240
    ds_read_b64_tr_b16 v[74:75], v13 offset:240
    ds_read_b64_tr_b16 v[78:79], v13 offset:272
    ds_read_b64_tr_b16 v[80:81], v14 offset:7680
    ds_read_b64_tr_b16 v[84:85], v13 offset:7680
    ds_read_b64_tr_b16 v[88:89], v13 offset:7712
    ds_read_b64_tr_b16 v[82:83], v14 offset:7920
    ds_read_b64_tr_b16 v[86:87], v13 offset:7920
    ds_read_b64_tr_b16 v[90:91], v13 offset:7952
    ds_read_b64_tr_b16 v[92:93], v14 offset:15360
    ds_read_b64_tr_b16 v[96:97], v13 offset:15360
    ds_read_b64_tr_b16 v[100:101], v13 offset:15392
    ds_read_b64_tr_b16 v[94:95], v14 offset:15600
    ds_read_b64_tr_b16 v[98:99], v13 offset:15600
    ds_read_b64_tr_b16 v[102:103], v13 offset:15632
    ds_read_b64_tr_b16 v[104:105], v14 offset:23040
    ds_read_b64_tr_b16 v[108:109], v13 offset:23040
    ds_read_b64_tr_b16 v[112:113], v13 offset:23072
    ds_read_b64_tr_b16 v[106:107], v14 offset:23280
    ds_read_b64_tr_b16 v[110:111], v13 offset:23280
    ds_read_b64_tr_b16 v[114:115], v13 offset:23312
    s_waitcnt lgkmcnt(15)
    v_mfma_f32_16x16x32_bf16 v[188:191], v[72:75], v[68:71], 0
    v_mfma_f32_16x16x32_bf16 v[192:195], v[76:79], v[68:71], 0
    s_waitcnt lgkmcnt(12)
    v_mfma_f32_16x16x32_bf16 v[188:191], v[84:87], v[80:83], v[188:191]
    v_mfma_f32_16x16x32_bf16 v[192:195], v[88:91], v[80:83], v[192:195]
    s_waitcnt lgkmcnt(6)
    v_mfma_f32_16x16x32_bf16 v[188:191], v[96:99], v[92:95], v[188:191]
    v_mfma_f32_16x16x32_bf16 v[192:195], v[100:103], v[92:95], v[192:195]
    s_waitcnt lgkmcnt(0)
    v_mfma_f32_16x16x32_bf16 v[188:191], v[108:111], v[104:107], v[188:191]
    v_mfma_f32_16x16x32_bf16 v[192:195], v[112:115], v[104:107], v[192:195]
    ds_read_b128 a[32:35], v11 offset:0
    ds_read_b128 a[36:39], v11 offset:1024
    ds_read_b128 a[40:43], v11 offset:2048
    ds_read_b128 a[44:47], v11 offset:3072
    ds_read_b128 a[48:51], v11 offset:4096
    s_nop 1
    v_cvt_pk_bf16_f32 v196, v188, v189
    v_cvt_pk_bf16_f32 v197, v190, v191
    v_cvt_pk_bf16_f32 v198, v192, v193
    v_cvt_pk_bf16_f32 v199, v194, s3
    buffer_store_dwordx4 v[196:199], v1, s[48:51], s64 offen sc1
    s_waitcnt lgkmcnt(4)
    v_mfma_f32_32x32x16_bf16 v[172:187], a[32:35], a[128:131], 0
    ds_read_b128 a[52:55], v11 offset:5120
    v_and_b32 v4, 15, v0
    s_add_u32 s79, s59, 1
    s_and_b32 s79, s79, 3
    s_mul_i32 s76, s79, 4224
    s_add_u32 m0, s73, s76
    s_lshl_b32 s79, s79, 14
    s_add_u32 s76, s77, s79
    v_lshlrev_b32 v4, 7, v4
    s_waitcnt lgkmcnt(4)
    v_mfma_f32_32x32x16_bf16 v[172:187], a[36:39], a[132:135], v[172:187]
    buffer_load_dwordx4 v228, s[24:27], s76 offen lds
    ds_read_b128 a[56:59], v11 offset:6144
    s_lshl_b32 s65, s54, 16
    s_lshl_b32 s66, s52, 10
    s_waitcnt lgkmcnt(3)
    v_mfma_f32_32x32x16_bf16 v[172:187], a[40:43], a[136:139], v[172:187]
    ds_read_b128 a[60:63], v11 offset:7168
    s_add_u32 s65, s65, s66
    s_add_u32 s65, s65, 1048576
    buffer_load_dwordx4 v229, s[24:27], s76 offen offset:1056 lds
    v_mfma_f32_32x32x16_bf16 v[172:187], a[44:47], a[140:143], v[172:187]
    buffer_load_dwordx4 v230, s[24:27], s76 offen offset:2112 lds
    ds_read_b128 a[32:35], v11 offset:8192
    v_lshrrev_b32 v8, 5, v0
    v_bfe_u32 v9, v0, 4, 1
    s_waitcnt lgkmcnt(3)
    v_mfma_f32_32x32x16_bf16 v[172:187], a[48:51], a[144:147], v[172:187]
    buffer_load_dwordx4 v231, s[24:27], s76 offen offset:3168 lds
    ds_read_b128 a[36:39], v11 offset:9216
    v_lshrrev_b32 v6, 3, v4
    v_mfma_f32_32x32x16_bf16 v[172:187], a[52:55], a[148:151], v[172:187]
    ds_read_b128 a[40:43], v11 offset:10240
    v_lshl_add_u32 v7, v8, 8, v6
    s_add_u32 s79, s59, 2
    s_and_b32 s79, s79, 3
    s_mul_i32 s76, s79, 4224
    s_add_u32 m0, s73, s76
    s_lshl_b32 s79, s79, 14
    s_add_u32 s76, s77, s79
    s_waitcnt lgkmcnt(3)
    v_mfma_f32_32x32x16_bf16 v[172:187], a[56:59], a[152:155], v[172:187]
    buffer_load_dwordx4 v228, s[24:27], s76 offen lds
    ds_read_b128 a[44:47], v11 offset:11264
    v_lshl_add_u32 v7, v9, 14, v7
    v_lshl_add_u32 v6, v8, 10, v6
    v_mfma_f32_32x32x16_bf16 v[172:187], a[60:63], a[156:159], v[172:187]
    buffer_load_dwordx4 v229, s[24:27], s76 offen offset:1056 lds
    ds_read_b128 a[48:51], v11 offset:12288
    v_lshl_add_u32 v6, v9, 9, v6
    s_waitcnt lgkmcnt(3)
    v_mfma_f32_32x32x16_bf16 v[172:187], a[32:35], a[160:163], v[172:187]
    ds_read_b128 a[52:55], v11 offset:13312
    s_lshr_b32 s64, s52, 1
    s_lshl_b32 s64, s64, 11
    s_and_b32 s66, s52, 1
    s_lshl_b32 s66, s66, 8
    v_mfma_f32_32x32x16_bf16 v[172:187], a[36:39], a[164:167], v[172:187]
    buffer_load_dwordx4 v230, s[24:27], s76 offen offset:2112 lds
    ds_read_b128 a[56:59], v11 offset:14336
    s_add_u32 s64, s64, s66
    s_add_u32 s64, s64, 57344
    v_add_u32 v6, s64, v6
    s_waitcnt lgkmcnt(3)
    v_mfma_f32_32x32x16_bf16 v[172:187], a[40:43], a[168:171], v[172:187]
    ds_read_b128 a[60:63], v11 offset:15360
    s_lshl_b32 s69, s88, 15
    s_lshl_b32 s66, s54, 10
    buffer_load_dwordx4 v231, s[24:27], s76 offen offset:3168 lds
    s_add_u32 s69, s69, s66
    s_add_u32 s69, s69, 2097152
    v_mfma_f32_32x32x16_bf16 v[172:187], a[44:47], a[172:175], v[172:187]
    ds_read_b128 a[32:35], v11 offset:16384
    s_add_u32 s79, s59, 3
    s_and_b32 s79, s79, 3
    s_mul_i32 s76, s79, 4224
    s_add_u32 m0, s73, s76
    s_lshl_b32 s79, s79, 14
    s_add_u32 s76, s77, s79
    s_lshl_b32 s75, s88, 7
    s_add_u32 s75, s75, 794624
    s_waitcnt lgkmcnt(3)
    v_mfma_f32_32x32x16_bf16 v[172:187], a[48:51], a[176:179], v[172:187]
    ds_read_b128 a[36:39], v11 offset:17408
    s_mov_b32 s70, 0x00003f80
    s_mov_b32 s71, 0x3f800000
    buffer_load_dwordx4 v228, s[24:27], s76 offen lds
    v_mfma_f32_32x32x16_bf16 v[172:187], a[52:55], a[180:183], v[172:187]
    buffer_load_dwordx4 v229, s[24:27], s76 offen offset:1056 lds
    ds_read_b128 a[40:43], v11 offset:18432
    v_add_u32 v10, 57344, v1
    v_and_b32 v5, 15, v0
    s_waitcnt lgkmcnt(3)
    v_mfma_f32_32x32x16_bf16 v[172:187], a[56:59], a[184:187], v[172:187]
    buffer_load_dwordx4 v230, s[24:27], s76 offen offset:2112 lds
    ds_read_b128 a[44:47], v11 offset:19456
    v_mov_b32 v12, v243
    v_mfma_f32_32x32x16_bf16 v[172:187], a[60:63], a[188:191], v[172:187]
    buffer_load_dwordx4 v231, s[24:27], s76 offen offset:3168 lds
    ds_read_b128 a[48:51], v11 offset:20480
    v_lshlrev_b32 v15, 3, v5
    s_waitcnt lgkmcnt(3)
    v_mfma_f32_32x32x16_bf16 v[172:187], a[32:35], a[192:195], v[172:187]
    ds_read_b128 a[52:55], v11 offset:21504
    v_lshl_add_u32 v15, v8, 2, v15
    v_lshlrev_b32 v5, 4, v5
    v_mfma_f32_32x32x16_bf16 v[172:187], a[36:39], a[196:199], v[172:187]
    ds_read_b128 a[56:59], v11 offset:22528
    v_lshl_add_u32 v14, v9, 10, v5
    s_branch L_page2
.p2align 12
L_stub2:
    s_branch L_stub6
L_page2:
    s_barrier
    s_waitcnt lgkmcnt(3)
    v_mfma_f32_32x32x16_bf16 v[172:187], a[40:43], a[200:203], v[172:187]
    ds_read_b128 a[60:63], v11 offset:23552
    v_lshl_add_u32 v14, v8, 9, v14
    v_lshrrev_b32 v9, 4, v0
    v_mfma_f32_32x32x16_bf16 v[172:187], a[44:47], a[204:207], v[172:187]
    ds_read_b128 a[32:35], v11 offset:24576
    s_add_u32 m0, s89, 0
    s_add_u32 s76, s83, 0
    v_mul_u32_u24 v23, 10752, v9
    s_waitcnt lgkmcnt(3)
    v_mfma_f32_32x32x16_bf16 v[172:187], a[48:51], a[208:211], v[172:187]
    buffer_load_dwordx4 v224, s[16:19], s76 offen lds
    ds_read_b128 a[36:39], v11 offset:25600
    v_add_u32 v23, v23, v5
    s_lshl_b32 s64, s52, 9
    v_mfma_f32_32x32x16_bf16 v[172:187], a[52:55], a[212:215], v[172:187]
    buffer_load_dwordx4 v225, s[16:19], s76 offen offset:1024 lds
    ds_read_b128 a[40:43], v11 offset:26624
    s_add_u32 s64, s64, 161792
    s_waitcnt lgkmcnt(3)
    v_mfma_f32_32x32x16_bf16 v[172:187], a[56:59], a[216:219], v[172:187]
    buffer_load_dwordx4 v226, s[16:19], s76 offen offset:2048 lds
    ds_read_b128 a[44:47], v11 offset:27648
    v_add_u32 v22, s64, v5
    v_mfma_f32_32x32x16_bf16 v[172:187], a[60:63], a[220:223], v[172:187]
    buffer_load_dwordx4 v227, s[16:19], s76 offen offset:3072 lds
    ds_read_b128 a[48:51], v11 offset:28672
    v_lshl_add_u32 v22, v8, 8, v22
    v_lshl_add_u32 v13, v9, 4, s64
    s_waitcnt lgkmcnt(3)
    v_mfma_f32_32x32x16_bf16 v[172:187], a[32:35], a[224:227], v[172:187]
    ds_read_b128 a[52:55], v11 offset:29696
    s_lshl2_add_u32 s80, s62, s52
    s_add_u32 m0, s89, 4096
    s_add_u32 s76, s83, 28672
    v_mfma_f32_32x32x16_bf16 v[172:187], a[36:39], a[228:231], v[172:187]
    s_mul_i32 s82, s80, 14336
    buffer_load_dwordx4 v224, s[16:19], s76 offen lds
    s_waitcnt lgkmcnt(2)
    v_mfma_f32_32x32x16_bf16 v[172:187], a[40:43], a[232:235], v[172:187]
    s_lshl_b32 s64, s63, 7
    s_add_u32 s82, s82, s64
    buffer_load_dwordx4 v225, s[16:19], s76 offen offset:1024 lds
    v_mfma_f32_32x32x16_bf16 v[172:187], a[44:47], a[236:239], v[172:187]
    s_min_u32 s67, s63, 6
    buffer_load_dwordx4 v226, s[16:19], s76 offen offset:2048 lds
    s_waitcnt lgkmcnt(0)
    v_mfma_f32_32x32x16_bf16 v[172:187], a[48:51], v[16:19], v[172:187]
    s_lshl_b32 s67, s67, 8
    s_add_u32 s68, s67, 729856
    v_mfma_f32_32x32x16_bf16 v[172:187], a[52:55], v[16:19], v[172:187]
    buffer_load_dwordx4 v227, s[16:19], s76 offen offset:3072 lds
    s_add_u32 s67, s67, 724480
    s_nop 9
    v_cvt_pk_bf16_f32 v60, v172, v173
    v_cvt_pk_bf16_f32 v61, v174, v175
    v_cvt_pk_bf16_f32 v62, v176, v177
    v_cvt_pk_bf16_f32 v63, v178, v179
    v_cvt_pk_bf16_f32 v64, v180, v181
    v_cvt_pk_bf16_f32 v65, v182, v183
    v_cvt_pk_bf16_f32 v66, v184, v185
    v_cvt_pk_bf16_f32 v67, v186, v187
    v_mfma_f32_32x32x16_bf16 v[204:219], v[24:27], v[60:63], 0
    s_nop 0
    v_mfma_f32_32x32x16_bf16 v[204:219], v[28:31], v[64:67], v[204:219]
    s_nop 11
    v_max3_f32 v68, v204, v205, v206
    v_min3_f32 v69, v204, v205, v206
    v_max3_f32 v68, v68, v207, v208
    v_min3_f32 v69, v69, v207, v208
    v_max3_f32 v68, v68, v209, v210
    v_min3_f32 v69, v69, v209, v210
    v_max3_f32 v68, v68, v212, v213
    v_min3_f32 v69, v69, v212, v213
    v_max3_f32 v68, v68, v214, v215
    v_min3_f32 v69, v69, v214, v215
    v_max3_f32 v68, v68, v216, v217
    v_min3_f32 v69, v69, v216, v217
    v_max_f32 v68, v68, v218
    v_max_f32 v69, -v69, -v218
    s_nop 1
    v_permlane32_swap_b32 v68, v69
    v_max_f32 v68, v68, v69
    v_mul_f32 v68, v68, -v21
    v_mov_b32 v69, v68
    s_nop 1
    v_permlane32_swap_b32 v68, v69
    v_pk_fma_f32 v[72:73], v[204:205], v[20:21], v[68:69] op_sel:[0,1,0] op_sel_hi:[1,1,0]
    v_pk_fma_f32 v[88:89], v[204:205], v[20:21], v[68:69] op_sel:[0,1,1] op_sel_hi:[1,1,1] neg_lo:[0,1,0] neg_hi:[0,1,0]
    v_exp_f32 v72, v72
    v_exp_f32 v73, v73
    v_exp_f32 v88, v88
    v_exp_f32 v89, v89
    v_pk_fma_f32 v[74:75], v[206:207], v[20:21], v[68:69] op_sel:[0,1,0] op_sel_hi:[1,1,0]
    v_pk_fma_f32 v[90:91], v[206:207], v[20:21], v[68:69] op_sel:[0,1,1] op_sel_hi:[1,1,1] neg_lo:[0,1,0] neg_hi:[0,1,0]
    v_exp_f32 v74, v74
    v_exp_f32 v75, v75
    v_exp_f32 v90, v90
    v_exp_f32 v91, v91
    v_pk_fma_f32 v[76:77], v[208:209], v[20:21], v[68:69] op_sel:[0,1,0] op_sel_hi:[1,1,0]
    v_pk_fma_f32 v[92:93], v[208:209], v[20:21], v[68:69] op_sel:[0,1,1] op_sel_hi:[1,1,1] neg_lo:[0,1,0] neg_hi:[0,1,0]
    v_exp_f32 v76, v76
    v_exp_f32 v77, v77
    v_exp_f32 v92, v92
    v_exp_f32 v93, v93
    v_pk_add_f32 v[60:61], v[72:73], v[74:75]
    v_pk_add_f32 v[62:63], v[88:89], v[90:91]
    v_pk_fma_f32 v[78:79], v[210:211], v[20:21], v[68:69] op_sel:[0,1,0] op_sel_hi:[1,1,0]
    v_pk_fma_f32 v[94:95], v[210:211], v[20:21], v[68:69] op_sel:[0,1,1] op_sel_hi:[1,1,1] neg_lo:[0,1,0] neg_hi:[0,1,0]
    v_exp_f32 v78, v78
    v_mov_b32 v79, 0
    v_exp_f32 v94, v94
    v_mov_b32 v95, 0
    v_pk_add_f32 v[60:61], v[60:61], v[76:77]
    v_pk_add_f32 v[62:63], v[62:63], v[92:93]
    v_pk_fma_f32 v[80:81], v[212:213], v[20:21], v[68:69] op_sel:[0,1,0] op_sel_hi:[1,1,0]
    v_pk_fma_f32 v[96:97], v[212:213], v[20:21], v[68:69] op_sel:[0,1,1] op_sel_hi:[1,1,1] neg_lo:[0,1,0] neg_hi:[0,1,0]
    v_exp_f32 v80, v80
    buffer_load_dwordx4 v[116:119], v1, s[48:51], s65 offen sc1
    s_add_u32 s66, s65, 4096
    buffer_load_dwordx4 v[120:123], v1, s[48:51], s66 offen sc1
    s_add_u32 s66, s65, 8192
    buffer_load_dwordx4 v[124:127], v1, s[48:51], s66 offen sc1
    s_add_u32 s66, s65, 12288
    buffer_load_dwordx4 v[128:131], v1, s[48:51], s66 offen sc1
    s_add_u32 s66, s65, 16384
    buffer_load_dwordx4 v[132:135], v1, s[48:51], s66 offen sc1
    s_add_u32 s66, s65, 20480
    buffer_load_dwordx4 v[136:139], v1, s[48:51], s66 offen sc1
    v_exp_f32 v81, v81
    s_add_u32 s66, s65, 24576
    buffer_load_dwordx4 v[140:143], v1, s[48:51], s66 offen sc1
    v_exp_f32 v96, v96
    v_exp_f32 v97, v97
    v_pk_add_f32 v[60:61], v[60:61], v[78:79]
    v_pk_add_f32 v[62:63], v[62:63], v[94:95]
    v_pk_fma_f32 v[82:83], v[214:215], v[20:21], v[68:69] op_sel:[0,1,0] op_sel_hi:[1,1,0]
    v_pk_fma_f32 v[98:99], v[214:215], v[20:21], v[68:69] op_sel:[0,1,1] op_sel_hi:[1,1,1] neg_lo:[0,1,0] neg_hi:[0,1,0]
    v_exp_f32 v82, v82
    v_exp_f32 v83, v83
    v_exp_f32 v98, v98
    s_add_u32 s66, s65, 28672
    buffer_load_dwordx4 v[144:147], v1, s[48:51], s66 offen sc1
    v_exp_f32 v99, v99
    v_pk_add_f32 v[60:61], v[60:61], v[80:81]
    v_pk_add_f32 v[62:63], v[62:63], v[96:97]
    v_pk_fma_f32 v[84:85], v[216:217], v[20:21], v[68:69] op_sel:[0,1,0] op_sel_hi:[1,1,0]
    v_pk_fma_f32 v[100:101], v[216:217], v[20:21], v[68:69] op_sel:[0,1,1] op_sel_hi:[1,1,1] neg_lo:[0,1,0] neg_hi:[0,1,0]
    v_exp_f32 v84, v84
    v_exp_f32 v85, v85
    v_exp_f32 v100, v100
    v_exp_f32_e64 v101, v101
    s_add_u32 s66, s65, 32768
    buffer_load_dwordx4 v[148:151], v1, s[48:51], s66 offen sc1
    v_pk_add_f32 v[60:61], v[60:61], v[82:83]
    v_pk_add_f32 v[62:63], v[62:63], v[98:99]
    v_pk_fma_f32 v[86:87], v[218:219], v[20:21], v[68:69] op_sel:[0,1,0] op_sel_hi:[1,1,0]
    v_pk_fma_f32 v[102:103], v[218:219], v[20:21], v[68:69] op_sel:[0,1,1] op_sel_hi:[1,1,1] neg_lo:[0,1,0] neg_hi:[0,1,0]
    v_exp_f32 v86, v86
    v_mov_b32 v87, 0
    v_exp_f32 v102, v102
    v_mov_b32 v103, 0
    v_pk_add_f32 v[60:61], v[60:61], v[84:85]
    s_add_u32 s66, s65, 36864
    buffer_load_dwordx4 v[152:155], v1, s[48:51], s66 offen sc1
    v_pk_add_f32 v[62:63], v[62:63], v[100:101]
    v_add_f32 v60, v60, v86
    v_add_f32 v62, v62, v102
    v_add_f32 v60, v60, v61
    v_add_f32 v61, v62, v63
    s_nop 1
    v_permlane32_swap_b32 v60, v61
    v_add_f32 v60, v60, v61
    v_rcp_f32 v60, v60
    s_nop 0
    v_mov_b32 v61, v60
    s_add_u32 s66, s65, 40960
    buffer_load_dwordx4 v[156:159], v1, s[48:51], s66 offen sc1
    v_permlane32_swap_b32 v60, v61
    v_pk_mul_f32 v[72:73], v[72:73], v[60:61] op_sel:[0,0] op_sel_hi:[1,0]
    v_cvt_pk_bf16_f32 v32, v72, v73
    v_pk_mul_f32 v[74:75], v[74:75], v[60:61] op_sel:[0,0] op_sel_hi:[1,0]
    v_cvt_pk_bf16_f32 v33, v74, v75
    v_pk_mul_f32 v[76:77], v[76:77], v[60:61] op_sel:[0,0] op_sel_hi:[1,0]
    v_cvt_pk_bf16_f32 v34, v76, v77
    v_pk_mul_f32 v[78:79], v[78:79], v[60:61] op_sel:[0,0] op_sel_hi:[1,0]
    v_cvt_pk_bf16_f32 v35, v78, v79
    s_add_u32 s66, s65, 45056
    buffer_load_dwordx4 v[160:163], v1, s[48:51], s66 offen sc1
    v_pk_mul_f32 v[80:81], v[80:81], v[60:61] op_sel:[0,0] op_sel_hi:[1,0]
    v_cvt_pk_bf16_f32 v36, v80, v81
    v_pk_mul_f32 v[82:83], v[82:83], v[60:61] op_sel:[0,0] op_sel_hi:[1,0]
    v_cvt_pk_bf16_f32 v37, v82, v83
    v_pk_mul_f32 v[84:85], v[84:85], v[60:61] op_sel:[0,0] op_sel_hi:[1,0]
    v_cvt_pk_bf16_f32 v38, v84, v85
    v_pk_mul_f32 v[86:87], v[86:87], v[60:61] op_sel:[0,0] op_sel_hi:[1,0]
    v_cvt_pk_bf16_f32 v39, v86, v87
    v_pk_mul_f32 v[88:89], v[88:89], v[60:61] op_sel:[0,1] op_sel_hi:[1,1]
    s_add_u32 s66, s65, 49152
    buffer_load_dwordx4 v[164:167], v1, s[48:51], s66 offen sc1
    v_cvt_pk_bf16_f32 v40, v88, v89
    v_pk_mul_f32 v[90:91], v[90:91], v[60:61] op_sel:[0,1] op_sel_hi:[1,1]
    v_cvt_pk_bf16_f32 v41, v90, v91
    v_pk_mul_f32 v[92:93], v[92:93], v[60:61] op_sel:[0,1] op_sel_hi:[1,1]
    v_cvt_pk_bf16_f32 v42, v92, v93
    v_pk_mul_f32 v[94:95], v[94:95], v[60:61] op_sel:[0,1] op_sel_hi:[1,1]
    v_cvt_pk_bf16_f32 v43, v94, v95
    v_pk_mul_f32 v[96:97], v[96:97], v[60:61] op_sel:[0,1] op_sel_hi:[1,1]
    v_cvt_pk_bf16_f32 v44, v96, v97
    s_add_u32 s66, s65, 53248
    buffer_load_dwordx4 v[168:171], v1, s[48:51], s66 offen sc1
    v_pk_mul_f32 v[98:99], v[98:99], v[60:61] op_sel:[0,1] op_sel_hi:[1,1]
    v_cvt_pk_bf16_f32 v45, v98, v99
    v_pk_mul_f32 v[100:101], v[100:101], v[60:61] op_sel:[0,1] op_sel_hi:[1,1]
    v_cvt_pk_bf16_f32 v46, v100, v101
    v_pk_mul_f32 v[102:103], v[102:103], v[60:61] op_sel:[0,1] op_sel_hi:[1,1]
    v_cvt_pk_bf16_f32 v47, v102, v103
    s_waitcnt vmcnt(22)
    v_and_b32 v8, 15, v0
    v_mul_u32_u24 v8, 1056, v8
    s_add_u32 s66, s65, 57344
    buffer_load_dwordx4 v[188:191], v1, s[48:51], s66 offen sc1
    v_and_b32 v9, 48, v0
    v_add3_u32 v8, v8, v9, s73
    ds_read_b128 a[64:67], v8 offset:0
    ds_read_b128 a[68:71], v8 offset:64
    ds_read_b128 a[72:75], v8 offset:128
    ds_read_b128 a[76:79], v8 offset:192
    ds_read_b128 a[80:83], v8 offset:256
    ds_read_b128 a[84:87], v8 offset:320
    ds_read_b128 a[88:91], v8 offset:384
    s_add_u32 s66, s65, 61440
    buffer_load_dwordx4 v[192:195], v1, s[48:51], s66 offen sc1
    ds_read_b128 a[92:95], v8 offset:448
    ds_read_b128 a[96:99], v8 offset:512
    ds_read_b128 a[100:103], v8 offset:576
    ds_read_b128 a[104:107], v8 offset:640
    ds_read_b128 a[108:111], v8 offset:704
    ds_read_b128 a[112:115], v8 offset:768
    ds_read_b128 a[116:119], v8 offset:832
    ds_read_b128 a[120:123], v8 offset:896
    ds_read_b128 a[124:127], v8 offset:960
L_kvsum:
    s_waitcnt vmcnt(15)
    v_lshlrev_b32 v204, 16, v116
    s_add_u32 m0, s89, 8192
    s_add_u32 s76, s83, 57344
    v_and_b32 v205, s74, v116
    v_lshlrev_b32 v206, 16, v117
    v_and_b32 v207, s74, v117
    v_lshlrev_b32 v208, 16, v118
    v_and_b32 v209, s74, v118
    v_lshlrev_b32 v210, 16, v119
    v_and_b32 v211, s74, v119
    v_xor_b32 v5, s3, v119
    s_waitcnt vmcnt(13)
    v_dot2c_f32_bf16 v204, s70, v120
    v_dot2c_f32_bf16 v205, s71, v120
    v_dot2c_f32_bf16 v206, s70, v121
    buffer_load_dwordx4 v224, s[16:19], s76 offen lds
    v_dot2c_f32_bf16 v207, s71, v121
    v_dot2c_f32_bf16 v208, s70, v122
    v_dot2c_f32_bf16 v209, s71, v122
    v_dot2c_f32_bf16 v210, s70, v123
    v_bitop3_b32 v5, v5, v123, s3 bitop3:0xf6
    v_dot2c_f32_bf16 v204, s70, v124
    v_dot2c_f32_bf16 v205, s71, v124
    v_dot2c_f32_bf16 v206, s70, v125
    v_dot2c_f32_bf16 v207, s71, v125
    v_dot2c_f32_bf16 v208, s70, v126
    v_dot2c_f32_bf16 v209, s71, v126
    v_dot2c_f32_bf16 v210, s70, v127
    buffer_load_dwordx4 v225, s[16:19], s76 offen offset:1024 lds
    v_bitop3_b32 v5, v5, v127, s3 bitop3:0xf6
    s_waitcnt vmcnt(13)
    v_dot2c_f32_bf16 v204, s70, v128
    v_dot2c_f32_bf16 v205, s71, v128
    v_dot2c_f32_bf16 v206, s70, v129
    v_dot2c_f32_bf16 v207, s71, v129
    v_dot2c_f32_bf16 v208, s70, v130
    v_dot2c_f32_bf16 v209, s71, v130
    v_dot2c_f32_bf16 v210, s70, v131
    v_bitop3_b32 v5, v5, v131, s3 bitop3:0xf6
    v_dot2c_f32_bf16 v204, s70, v132
    v_dot2c_f32_bf16 v205, s71, v132
    buffer_load_dwordx4 v226, s[16:19], s76 offen offset:2048 lds
    v_dot2c_f32_bf16 v206, s70, v133
    v_dot2c_f32_bf16 v207, s71, v133
    v_dot2c_f32_bf16 v208, s70, v134
    v_dot2c_f32_bf16 v209, s71, v134
    v_dot2c_f32_bf16 v210, s70, v135
    v_bitop3_b32 v5, v5, v135, s3 bitop3:0xf6
    s_waitcnt vmcnt(12)
    v_dot2c_f32_bf16 v204, s70, v136
    v_dot2c_f32_bf16 v205, s71, v136
    v_dot2c_f32_bf16 v206, s70, v137
    v_dot2c_f32_bf16 v207, s71, v137
    v_dot2c_f32_bf16 v208, s70, v138
    v_dot2c_f32_bf16 v209, s71, v138
    buffer_load_dwordx4 v227, s[16:19], s76 offen offset:3072 lds
    v_dot2c_f32_bf16 v210, s70, v139
    v_bitop3_b32 v5, v5, v139, s3 bitop3:0xf6
    v_dot2c_f32_bf16 v204, s70, v140
    v_dot2c_f32_bf16 v205, s71, v140
    v_dot2c_f32_bf16 v206, s70, v141
    v_dot2c_f32_bf16 v207, s71, v141
    v_dot2c_f32_bf16 v208, s70, v142
    v_dot2c_f32_bf16 v209, s71, v142
    v_dot2c_f32_bf16 v210, s70, v143
    v_bitop3_b32 v5, v5, v143, s3 bitop3:0xf6
    s_waitcnt vmcnt(11)
    v_dot2c_f32_bf16 v204, s70, v144
    s_add_u32 m0, s89, 12288
    s_add_u32 s76, s83, 86016
    v_dot2c_f32_bf16 v205, s71, v144
    v_dot2c_f32_bf16 v206, s70, v145
    v_dot2c_f32_bf16 v207, s71, v145
    v_dot2c_f32_bf16 v208, s70, v146
    v_dot2c_f32_bf16 v209, s71, v146
    v_dot2c_f32_bf16 v210, s70, v147
    v_bitop3_b32 v5, v5, v147, s3 bitop3:0xf6
    v_dot2c_f32_bf16 v204, s70, v148
    v_dot2c_f32_bf16 v205, s71, v148
    v_dot2c_f32_bf16 v206, s70, v149
    v_dot2c_f32_bf16 v207, s71, v149
    v_dot2c_f32_bf16 v208, s70, v150
    buffer_load_dwordx4 v224, s[16:19], s76 offen lds
    v_dot2c_f32_bf16 v209, s71, v150
    v_dot2c_f32_bf16 v210, s70, v151
    v_bitop3_b32 v5, v5, v151, s3 bitop3:0xf6
    s_waitcnt vmcnt(10)
    v_dot2c_f32_bf16 v204, s70, v152
    v_dot2c_f32_bf16 v205, s71, v152
    v_dot2c_f32_bf16 v206, s70, v153
    v_dot2c_f32_bf16 v207, s71, v153
    v_dot2c_f32_bf16 v208, s70, v154
    v_dot2c_f32_bf16 v209, s71, v154
    v_dot2c_f32_bf16 v210, s70, v155
    v_bitop3_b32 v5, v5, v155, s3 bitop3:0xf6
    buffer_load_dwordx4 v225, s[16:19], s76 offen offset:1024 lds
    v_dot2c_f32_bf16 v204, s70, v156
    v_dot2c_f32_bf16 v205, s71, v156
    v_dot2c_f32_bf16 v206, s70, v157
    v_dot2c_f32_bf16 v207, s71, v157
    v_dot2c_f32_bf16 v208, s70, v158
    v_dot2c_f32_bf16 v209, s71, v158
    v_dot2c_f32_bf16 v210, s70, v159
    v_bitop3_b32 v5, v5, v159, s3 bitop3:0xf6
    s_waitcnt vmcnt(9)
    v_dot2c_f32_bf16 v204, s70, v160
    v_dot2c_f32_bf16 v205, s71, v160
    v_dot2c_f32_bf16 v206, s70, v161
    v_dot2c_f32_bf16 v207, s71, v161
    v_dot2c_f32_bf16 v208, s70, v162
    v_dot2c_f32_bf16 v209, s71, v162
    v_dot2c_f32_bf16 v210, s70, v163
    v_bitop3_b32 v5, v5, v163, s3 bitop3:0xf6
    v_dot2c_f32_bf16 v204, s70, v164
    v_dot2c_f32_bf16 v205, s71, v164
    v_dot2c_f32_bf16 v206, s70, v165
    v_dot2c_f32_bf16 v207, s71, v165
    v_dot2c_f32_bf16 v208, s70, v166
    v_dot2c_f32_bf16 v209, s71, v166
    v_dot2c_f32_bf16 v210, s70, v167
    v_bitop3_b32 v5, v5, v167, s3 bitop3:0xf6
    buffer_load_dwordx4 v[180:183], v23, s[48:51], s67 offen sc1
    s_waitcnt vmcnt(9)
    v_dot2c_f32_bf16 v204, s70, v168
    v_dot2c_f32_bf16 v205, s71, v168
    v_dot2c_f32_bf16 v206, s70, v169
    v_dot2c_f32_bf16 v207, s71, v169
    v_dot2c_f32_bf16 v208, s70, v170
    v_dot2c_f32_bf16 v209, s71, v170
    v_dot2c_f32_bf16 v210, s70, v171
    v_bitop3_b32 v5, v5, v171, s3 bitop3:0xf6
    s_waitcnt vmcnt(8)
    v_dot2c_f32_bf16 v204, s70, v188
    v_dot2c_f32_bf16 v205, s71, v188
    v_dot2c_f32_bf16 v206, s70, v189
    v_dot2c_f32_bf16 v207, s71, v189
    buffer_load_dwordx4 v[184:187], v23, s[48:51], s68 offen sc1
    v_dot2c_f32_bf16 v208, s70, v190
    v_dot2c_f32_bf16 v209, s71, v190
    v_dot2c_f32_bf16 v210, s70, v191
    v_bitop3_b32 v5, v5, v191, s3 bitop3:0xf6
    s_waitcnt vmcnt(8)
    v_dot2c_f32_bf16 v204, s70, v192
    v_dot2c_f32_bf16 v205, s71, v192
    v_dot2c_f32_bf16 v206, s70, v193
    v_dot2c_f32_bf16 v207, s71, v193
    v_dot2c_f32_bf16 v208, s70, v194
    v_dot2c_f32_bf16 v209, s71, v194
    v_dot2c_f32_bf16 v210, s70, v195
    v_bitop3_b32 v5, v5, v195, s3 bitop3:0xf6
    v_cmp_le_u32 vcc, 0x10000, v5
    s_nop 0
    s_cbranch_vccnz L_kvretry
L_kvok:
    v_cvt_pk_bf16_f32 v244, v204, v205
    v_cvt_pk_bf16_f32 v245, v206, v207
    v_cvt_pk_bf16_f32 v246, v208, v209
    v_cvt_pk_bf16_f32 v247, v210, 0
    ds_write_b128 v6, v[244:247]
    s_waitcnt lgkmcnt(0)
    s_barrier
    ds_read_b128 a[32:35], v10 offset:0
    ds_read_b128 a[36:39], v10 offset:1024
    ds_read_b128 a[40:43], v10 offset:2048
    ds_read_b128 a[44:47], v10 offset:3072
    s_waitcnt lgkmcnt(3)
    v_mfma_f32_32x32x16_bf16 v[188:203], a[32:35], v[32:35], 0
    s_waitcnt lgkmcnt(2)
    v_mfma_f32_32x32x16_bf16 v[188:203], a[36:39], v[36:39], v[188:203]
    s_waitcnt lgkmcnt(1)
    v_mfma_f32_32x32x16_bf16 v[188:203], a[40:43], v[40:43], v[188:203]
    s_waitcnt lgkmcnt(0)
    v_mfma_f32_32x32x16_bf16 v[188:203], a[44:47], v[44:47], v[188:203]
    s_nop 11
    v_add_f32 v8, 0x358637bd, v200
    v_rcp_f32 v8, v8
    s_nop 0
    v_mov_b32 v9, v8
    s_nop 1
    v_permlane32_swap_b32 v8, v9
    v_mov_b32_e64 v8, v9
    v_pk_mul_f32 v[188:189], v[188:189], v[8:9]
    v_cvt_pk_bf16_f32 v60, v188, v189
    v_pk_mul_f32 v[190:191], v[190:191], v[8:9]
    v_cvt_pk_bf16_f32 v61, v190, v191
    v_pk_mul_f32 v[192:193], v[192:193], v[8:9]
    v_cvt_pk_bf16_f32 v62, v192, v193
    v_pk_mul_f32 v[194:195], v[194:195], v[8:9]
    v_cvt_pk_bf16_f32 v63, v194, v195
    buffer_store_dwordx4 v[60:63], v7, s[48:51], s69 offen sc1
    v_pk_mul_f32 v[196:197], v[196:197], v[8:9]
    v_cvt_pk_bf16_f32 v64, v196, v197
    v_pk_mul_f32 v[198:199], v[198:199], v[8:9]
    v_cvt_pk_bf16_f32 v65, v198, v199
    v_pk_mul_f32 v[200:201], v[200:201], v[8:9]
    v_cvt_pk_bf16_f32 v66, v200, v201
    v_pk_mul_f32 v[202:203], v[202:203], v[8:9]
    v_cvt_pk_bf16_f32 v67, v202, v203
    s_mov_b32 exec_lo, 0
    v_mov_b32 v66, 0
    v_mov_b32 v67, 0
    s_mov_b32 exec_lo, -1
    buffer_store_dwordx4 v[64:67], v7, s[48:51], s69 offen offset:512 sc1
    s_cmp_ge_u32 s57, 14
    s_cbranch_scc1 L_helper
    v_lshrrev_b32 v4, 2, v0
    v_lshrrev_b32 v5, 5, v0
    v_lshl_add_u32 v4, v5, 3, v4
    v_bfe_u32 v5, v4, 1, 2
    v_lshlrev_b32 v4, 7, v4
    v_lshl_add_u32 v4, v5, 5, v4
    v_and_b32 v5, 3, v0
    v_lshl_add_u32 v4, v5, 3, v4
    v_xor_b32 v5, 32, v4
    v_xor_b32 v6, 64, v4
    v_xor_b32 v7, 96, v4
    s_waitcnt vmcnt(4)
    s_barrier
    ds_read_b64_tr_b16 a[128:129], v4 offset:0
    s_add_u32 s77, s52, 0
    s_and_b32 s77, s77, 3
    ds_read_b64_tr_b16 a[130:131], v4 offset:1024
    ds_read_b64_tr_b16 a[132:133], v5 offset:0
    ds_read_b64_tr_b16 a[134:135], v5 offset:1024
    ds_read_b64_tr_b16 a[136:137], v6 offset:0
    ds_read_b64_tr_b16 a[138:139], v6 offset:1024
    s_lshl_b32 s77, s77, 16
    s_add_u32 s77, s77, s86
    ds_read_b64_tr_b16 a[140:141], v7 offset:0
    ds_read_b64_tr_b16 a[142:143], v7 offset:1024
    ds_read_b64_tr_b16 a[144:145], v6 offset:3584
    ds_read_b64_tr_b16 a[146:147], v6 offset:4608
    ds_read_b64_tr_b16 a[148:149], v7 offset:3584
    s_add_u32 s79, s59, 0
    s_and_b32 s79, s79, 3
    s_mul_i32 s76, s79, 4224
    s_add_u32 m0, s73, s76
    s_lshl_b32 s79, s79, 14
    s_add_u32 s76, s77, s79
    ds_read_b64_tr_b16 a[150:151], v7 offset:4608
    ds_read_b64_tr_b16 a[152:153], v4 offset:3584
    ds_read_b64_tr_b16 a[154:155], v4 offset:4608
    ds_read_b64_tr_b16 a[156:157], v5 offset:3584
    ds_read_b64_tr_b16 a[158:159], v5 offset:4608
    ds_read_b64_tr_b16 a[160:161], v4 offset:7168
    buffer_load_dwordx4 v228, s[24:27], s76 offen lds
    ds_read_b64_tr_b16 a[162:163], v4 offset:8192
    ds_read_b64_tr_b16 a[164:165], v5 offset:7168
    ds_read_b64_tr_b16 a[166:167], v5 offset:8192
    ds_read_b64_tr_b16 a[168:169], v6 offset:7168
    ds_read_b64_tr_b16 a[170:171], v6 offset:8192
    buffer_load_dwordx4 v229, s[24:27], s76 offen offset:1056 lds
    ds_read_b64_tr_b16 a[172:173], v7 offset:7168
    ds_read_b64_tr_b16 a[174:175], v7 offset:8192
    ds_read_b64_tr_b16 a[176:177], v6 offset:10752
    ds_read_b64_tr_b16 a[178:179], v6 offset:11776
    ds_read_b64_tr_b16 a[180:181], v7 offset:10752
    buffer_load_dwordx4 v230, s[24:27], s76 offen offset:2112 lds
    ds_read_b64_tr_b16 a[182:183], v7 offset:11776
    ds_read_b64_tr_b16 a[184:185], v4 offset:10752
    ds_read_b64_tr_b16 a[186:187], v4 offset:11776
    ds_read_b64_tr_b16 a[188:189], v5 offset:10752
    ds_read_b64_tr_b16 a[190:191], v5 offset:11776
    ds_read_b64_tr_b16 a[192:193], v4 offset:14336
    buffer_load_dwordx4 v231, s[24:27], s76 offen offset:3168 lds
    ds_read_b64_tr_b16 a[194:195], v4 offset:15360
    ds_read_b64_tr_b16 a[196:197], v5 offset:14336
    ds_read_b64_tr_b16 a[198:199], v5 offset:15360
    ds_read_b64_tr_b16 a[200:201], v6 offset:14336
    ds_read_b64_tr_b16 a[202:203], v6 offset:15360
    s_add_u32 s79, s59, 1
    s_and_b32 s79, s79, 3
    s_mul_i32 s76, s79, 4224
    s_add_u32 m0, s73, s76
    s_lshl_b32 s79, s79, 14
    s_add_u32 s76, s77, s79
    ds_read_b64_tr_b16 a[204:205], v7 offset:14336
    ds_read_b64_tr_b16 a[206:207], v7 offset:15360
    ds_read_b64_tr_b16 a[208:209], v6 offset:17920
    ds_read_b64_tr_b16 a[210:211], v6 offset:18944
    ds_read_b64_tr_b16 a[212:213], v7 offset:17920
    buffer_load_dwordx4 v228, s[24:27], s76 offen lds
    ds_read_b64_tr_b16 a[214:215], v7 offset:18944
    ds_read_b64_tr_b16 a[216:217], v4 offset:17920
    ds_read_b64_tr_b16 a[218:219], v4 offset:18944
    ds_read_b64_tr_b16 a[220:221], v5 offset:17920
    ds_read_b64_tr_b16 a[222:223], v5 offset:18944
    ds_read_b64_tr_b16 a[224:225], v4 offset:21504
    buffer_load_dwordx4 v229, s[24:27], s76 offen offset:1056 lds
    ds_read_b64_tr_b16 a[226:227], v4 offset:22528
    ds_read_b64_tr_b16 a[228:229], v5 offset:21504
    ds_read_b64_tr_b16 a[230:231], v5 offset:22528
    ds_read_b64_tr_b16 a[232:233], v6 offset:21504
    ds_read_b64_tr_b16 a[234:235], v6 offset:22528
    buffer_load_dwordx4 v230, s[24:27], s76 offen offset:2112 lds
    ds_read_b64_tr_b16 a[236:237], v7 offset:21504
    ds_read_b64_tr_b16 a[238:239], v7 offset:22528
    ds_read_b64_tr_b16 a[240:241], v6 offset:25088
    ds_read_b64_tr_b16 a[242:243], v6 offset:26112
    ds_read_b64_tr_b16 a[244:245], v7 offset:25088
    buffer_load_dwordx4 v231, s[24:27], s76 offen offset:3168 lds
    ds_read_b64_tr_b16 a[246:247], v7 offset:26112
    ds_read_b64_tr_b16 a[248:249], v4 offset:25088
    ds_read_b64_tr_b16 a[250:251], v4 offset:26112
    ds_read_b64_tr_b16 a[252:253], v5 offset:25088
    ds_read_b64_tr_b16 a[254:255], v5 offset:26112
    s_waitcnt vmcnt(8)
    s_mov_b64 exec, 1
    buffer_atomic_add v3, off, s[48:51], s75 sc1
    s_mov_b64 exec, -1
    s_lshr_b32 s83, s80, 1
    s_lshl_b32 s66, s83, 7
    s_add_u32 s79, s59, 2
    s_and_b32 s79, s79, 3
    s_mul_i32 s76, s79, 4224
    s_add_u32 m0, s73, s76
    s_lshl_b32 s79, s79, 14
    s_add_u32 s76, s77, s79
    s_add_u32 s66, s66, 794624
    s_lshl_b32 s65, s80, 14
    s_add_u32 s65, s65, 2097152
    v_xor_b32 v180, s12, v180
    v_xor_b32 v181, s13, v181
    buffer_load_dwordx4 v228, s[24:27], s76 offen lds
    v_xor_b32 v182, s14, v182
    v_xor_b32 v183, s15, v183
    v_xor_b32 v184, s12, v184
    v_xor_b32 v185, s13, v185
    buffer_load_dwordx4 v229, s[24:27], s76 offen offset:1056 lds
    v_xor_b32 v186, s14, v186
    v_xor_b32 v187, s15, v187
    v_or3_b32 v18, v180, v181, v182
    v_or3_b32 v18, v18, v183, v184
    v_or3_b32 v18, v18, v185, v186
    buffer_load_dwordx4 v230, s[24:27], s76 offen offset:2112 lds
    v_or_b32 v18, v18, v187
    v_and_b32 v18, 0xff, v18
    v_cmp_ne_u32 vcc, 0, v18
    s_nop 0
    s_cbranch_vccnz L_gateretry
L_gateok:
    buffer_load_dwordx4 v231, s[24:27], s76 offen offset:3168 lds
    v_permlane32_swap_b32 v180, v184
    v_permlane32_swap_b32 v181, v185
    v_permlane32_swap_b32 v182, v186
    v_permlane32_swap_b32 v183, v187
    v_add_f32 v180, v180, v184
    s_add_u32 s79, s59, 3
    s_and_b32 s79, s79, 3
    s_mul_i32 s76, s79, 4224
    s_add_u32 m0, s73, s76
    s_lshl_b32 s79, s79, 14
    s_add_u32 s76, s77, s79
    v_add_f32 v181, v181, v185
    v_add_f32 v182, v182, v186
    v_add_f32 v183, v183, v187
    v_mov_b32 v184, v180
    buffer_load_dwordx4 v228, s[24:27], s76 offen lds
    v_mov_b32 v185, v181
    v_mov_b32 v186, v182
    v_mov_b32 v187, v183
    v_permlane16_swap_b32 v180, v184
    v_permlane16_swap_b32 v181, v185
    buffer_load_dwordx4 v229, s[24:27], s76 offen offset:1056 lds
    v_permlane16_swap_b32 v182, v186
    v_permlane16_swap_b32 v183, v187
    v_add_f32 v180, v180, v184
    v_add_f32 v181, v181, v185
    buffer_load_dwordx4 v230, s[24:27], s76 offen offset:2112 lds
    v_add_f32 v182, v182, v186
    v_add_f32 v183, v183, v187
    v_cvt_pk_bf16_f32 v184, v180, v181
    v_cvt_pk_bf16_f32 v185, v182, v183
    v_lshlrev_b32 v180, 16, v184
    buffer_load_dwordx4 v231, s[24:27], s76 offen offset:3168 lds
    v_and_b32 v181, s74, v184
    v_lshlrev_b32 v182, 16, v185
    v_and_b32 v183, s74, v185
    ds_write_b128 v22, v[180:183]
    ds_read_b128 v[144:147], v13 offset:0
    ds_read_b128 v[148:151], v13 offset:64
    ds_read_b128 v[152:155], v13 offset:128
    ds_read_b128 v[156:159], v13 offset:192
    s_mul_i32 s78, s53, 16
    s_mov_b64 exec, 1
    s_branch L_page3
.p2align 12
L_stub3:
    s_branch L_stub7
L_page3:
    s_mov_b32 s72, 524288
L_poll2:
    v_mov_b32 v9, 0
    buffer_atomic_add v9, off, s[48:51], s66 sc0 sc1
    s_sub_u32 s72, s72, 1
    s_cbranch_scc1 L_pollx2
    s_waitcnt vmcnt(0)
    v_cmp_ne_u32 vcc, s78, v9
    s_nop 0
    s_cbranch_vccnz L_poll2
L_pollx2:
    s_mov_b64 exec, -1
    buffer_load_dwordx4 v[64:67], v1, s[48:51], s65 offen offset:0 sc1
    buffer_load_dwordx4 v[68:71], v1, s[48:51], s65 offen offset:1024 sc1
    buffer_load_dwordx4 v[72:75], v1, s[48:51], s65 offen offset:2048 sc1
    buffer_load_dwordx4 v[76:79], v1, s[48:51], s65 offen offset:3072 sc1
    s_add_u32 s65, s65, 4096
    buffer_load_dwordx4 v[80:83], v1, s[48:51], s65 offen offset:0 sc1
    buffer_load_dwordx4 v[84:87], v1, s[48:51], s65 offen offset:1024 sc1
    buffer_load_dwordx4 v[88:91], v1, s[48:51], s65 offen offset:2048 sc1
    buffer_load_dwordx4 v[92:95], v1, s[48:51], s65 offen offset:3072 sc1
    s_add_u32 s65, s65, 4096
    buffer_load_dwordx4 v[96:99], v1, s[48:51], s65 offen offset:0 sc1
    buffer_load_dwordx4 v[100:103], v1, s[48:51], s65 offen offset:1024 sc1
    buffer_load_dwordx4 v[104:107], v1, s[48:51], s65 offen offset:2048 sc1
    v_and_b32 v10, 15, v0
    v_mul_u32_u24 v10, 1056, v10
    v_and_b32_e64 v11, 48, v0
    v_add3_u32 v10, v10, v11, s73
    ds_read_b128 a[0:3], v10 offset:0
    ds_read_b128 a[4:7], v10 offset:64
    ds_read_b128 a[8:11], v10 offset:128
    ds_read_b128 a[12:15], v10 offset:192
    ds_read_b128 a[16:19], v10 offset:256
    ds_read_b128 a[20:23], v10 offset:320
    ds_read_b128 a[24:27], v10 offset:384
    ds_read_b128 a[28:31], v10 offset:448
    ds_read_b128 a[32:35], v10 offset:512
    ds_read_b128 a[36:39], v10 offset:576
    ds_read_b128 a[40:43], v10 offset:640
    ds_read_b128 a[44:47], v10 offset:704
    ds_read_b128 a[48:51], v10 offset:768
    ds_read_b128 a[52:55], v10 offset:832
    ds_read_b128 a[56:59], v10 offset:896
    ds_read_b128 a[60:63], v10 offset:960
    s_and_b32 s55, s60, 1
    s_mul_i32 s55, s55, 7
    s_add_u32 s55, s55, s63
    s_lshr_b32 s56, s60, 1
    s_and_b32 s64, s62, 3
    s_lshl2_add_u32 s56, s56, s64
    v_permlane16_swap_b32 v248, v250
    v_permlane16_swap_b32 v249, v251
    v_permlane16_swap_b32 v252, v254
    v_permlane16_swap_b32 v253, v255
    v_lshlrev_b32 v192, 16, v248
    v_and_b32 v193, s74, v248
    v_lshlrev_b32 v194, 16, v249
    v_and_b32 v195, s74, v249
    v_lshlrev_b32 v196, 16, v250
    v_and_b32 v197, s74, v250
    v_lshlrev_b32 v198, 16, v251
    v_and_b32 v199, s74, v251
    v_lshlrev_b32 v200, 16, v252
    v_and_b32 v201, s74, v252
    v_lshlrev_b32 v202, 16, v253
    v_and_b32 v203, s74, v253
    v_lshlrev_b32 v204, 16, v254
    v_and_b32 v205, s74, v254
    v_lshlrev_b32 v206, 16, v255
    v_and_b32 v207, s74, v255
    s_mul_i32 s69, s83, 28672
    s_lshl_b32 s64, s63, 12
    s_add_u32 s69, s69, s64
    s_and_b32 s64, s52, 1
    s_lshl_b32 s64, s64, 8
    s_add_u32 s69, s69, s64
    s_add_u32 s69, s69, 4194304
    s_lshl_b32 s75, s83, 7
    s_add_u32 s75, s75, 802816
    s_lshl_b32 s70, s63, 14
    s_lshl_b32 s64, s80, 7
    s_add_u32 s70, s70, s64
    s_add_u32 s70, s70, 131072
    s_mov_b32 s71, 0x3f803f80
    s_mul_i32 s88, s55, 61440
    s_mul_i32 s89, s52, 15360
    s_add_u32 s88, s88, s89
    s_add_u32 s88, s88, 6291456
    s_waitcnt vmcnt(10) lgkmcnt(15)
    v_mfma_f32_16x16x32_bf16 v[128:131], a[128:131], v[64:67], 0
    buffer_load_dwordx4 v[108:111], v1, s[48:51], s65 offen offset:3072 sc1
    ds_read_b64_tr_b16 a[128:129], v4 offset:28672
    ds_read_b64_tr_b16 a[130:131], v4 offset:29696
    v_mfma_f32_16x16x32_bf16 v[132:135], a[132:135], v[64:67], 0
    ds_read_b64_tr_b16 a[132:133], v5 offset:28672
    ds_read_b64_tr_b16 a[134:135], v5 offset:29696
    v_mfma_f32_16x16x32_bf16 v[136:139], a[136:139], v[64:67], 0
    ds_read_b64_tr_b16 a[136:137], v6 offset:28672
    ds_read_b64_tr_b16 a[138:139], v6 offset:29696
    v_mfma_f32_16x16x32_bf16 v[140:143], a[140:143], v[64:67], 0
    ds_read_b64_tr_b16 a[140:141], v7 offset:28672
    ds_read_b64_tr_b16 a[142:143], v7 offset:29696
    s_waitcnt vmcnt(10)
    v_mfma_f32_16x16x32_bf16 v[128:131], a[144:147], v[68:71], v[128:131]
    ds_read_b64_tr_b16 a[144:145], v6 offset:32256
    ds_read_b64_tr_b16 a[146:147], v6 offset:33280
    s_add_u32 s65, s65, 4096
    buffer_load_dwordx4 v[112:115], v1, s[48:51], s65 offen offset:0 sc1
    v_mfma_f32_16x16x32_bf16 v[132:135], a[148:151], v[68:71], v[132:135]
    ds_read_b64_tr_b16 a[148:149], v7 offset:32256
    ds_read_b64_tr_b16 a[150:151], v7 offset:33280
    v_mfma_f32_16x16x32_bf16 v[136:139], a[152:155], v[68:71], v[136:139]
    ds_read_b64_tr_b16 a[152:153], v4 offset:32256
    ds_read_b64_tr_b16 a[154:155], v4 offset:33280
    v_mfma_f32_16x16x32_bf16 v[140:143], a[156:159], v[68:71], v[140:143]
    ds_read_b64_tr_b16 a[156:157], v5 offset:32256
    ds_read_b64_tr_b16 a[158:159], v5 offset:33280
    s_waitcnt vmcnt(10)
    v_mfma_f32_16x16x32_bf16 v[128:131], a[160:163], v[72:75], v[128:131]
    buffer_load_dwordx4 v[116:119], v1, s[48:51], s65 offen offset:1024 sc1
    ds_read_b64_tr_b16 a[160:161], v4 offset:35840
    ds_read_b64_tr_b16 a[162:163], v4 offset:36864
    v_mfma_f32_16x16x32_bf16 v[132:135], a[164:167], v[72:75], v[132:135]
    ds_read_b64_tr_b16 a[164:165], v5 offset:35840
    ds_read_b64_tr_b16 a[166:167], v5 offset:36864
    v_mfma_f32_16x16x32_bf16 v[136:139], a[168:171], v[72:75], v[136:139]
    ds_read_b64_tr_b16 a[168:169], v6 offset:35840
    ds_read_b64_tr_b16 a[170:171], v6 offset:36864
    v_mfma_f32_16x16x32_bf16 v[140:143], a[172:175], v[72:75], v[140:143]
    ds_read_b64_tr_b16 a[172:173], v7 offset:35840
    ds_read_b64_tr_b16 a[174:175], v7 offset:36864
    s_waitcnt vmcnt(10)
    v_mfma_f32_16x16x32_bf16 v[128:131], a[176:179], v[76:79], v[128:131]
    buffer_load_dwordx4 v[120:123], v1, s[48:51], s65 offen offset:2048 sc1
    ds_read_b64_tr_b16 a[176:177], v6 offset:39424
    ds_read_b64_tr_b16 a[178:179], v6 offset:40448
    v_mfma_f32_16x16x32_bf16 v[132:135], a[180:183], v[76:79], v[132:135]
    ds_read_b64_tr_b16 a[180:181], v7 offset:39424
    ds_read_b64_tr_b16 a[182:183], v7 offset:40448
    v_mfma_f32_16x16x32_bf16 v[136:139], a[184:187], v[76:79], v[136:139]
    ds_read_b64_tr_b16 a[184:185], v4 offset:39424
    ds_read_b64_tr_b16 a[186:187], v4 offset:40448
    v_mfma_f32_16x16x32_bf16 v[140:143], a[188:191], v[76:79], v[140:143]
    ds_read_b64_tr_b16 a[188:189], v5 offset:39424
    ds_read_b64_tr_b16 a[190:191], v5 offset:40448
    s_waitcnt vmcnt(10)
    v_mfma_f32_16x16x32_bf16 v[128:131], a[192:195], v[80:83], v[128:131]
    buffer_load_dwordx4 v[124:127], v1, s[48:51], s65 offen offset:3072 sc1
    ds_read_b64_tr_b16 a[192:193], v4 offset:43008
    ds_read_b64_tr_b16 a[194:195], v4 offset:44032
    v_mfma_f32_16x16x32_bf16 v[132:135], a[196:199], v[80:83], v[132:135]
    ds_read_b64_tr_b16 a[196:197], v5 offset:43008
    ds_read_b64_tr_b16 a[198:199], v5 offset:44032
    v_mfma_f32_16x16x32_bf16 v[136:139], a[200:203], v[80:83], v[136:139]
    ds_read_b64_tr_b16 a[200:201], v6 offset:43008
    ds_read_b64_tr_b16 a[202:203], v6 offset:44032
    v_mfma_f32_16x16x32_bf16 v[140:143], a[204:207], v[80:83], v[140:143]
    ds_read_b64_tr_b16 a[204:205], v7 offset:43008
    ds_read_b64_tr_b16 a[206:207], v7 offset:44032
    s_waitcnt vmcnt(10)
    v_mfma_f32_16x16x32_bf16 v[128:131], a[208:211], v[84:87], v[128:131]
    ds_read_b64_tr_b16 a[208:209], v6 offset:46592
    ds_read_b64_tr_b16 a[210:211], v6 offset:47616
    s_waitcnt lgkmcnt(15)
    v_mfma_f32_16x16x32_bf16 v[132:135], a[212:215], v[84:87], v[132:135]
    ds_read_b64_tr_b16 a[212:213], v7 offset:46592
    ds_read_b64_tr_b16 a[214:215], v7 offset:47616
    s_add_u32 s77, s52, 2
    s_and_b32 s77, s77, 3
    v_mfma_f32_16x16x32_bf16 v[136:139], a[216:219], v[84:87], v[136:139]
    ds_read_b64_tr_b16 a[216:217], v4 offset:46592
    ds_read_b64_tr_b16 a[218:219], v4 offset:47616
    v_mfma_f32_16x16x32_bf16 v[140:143], a[220:223], v[84:87], v[140:143]
    ds_read_b64_tr_b16 a[220:221], v5 offset:46592
    ds_read_b64_tr_b16 a[222:223], v5 offset:47616
    s_lshl_b32 s77, s77, 16
    s_add_u32 s77, s77, s86
    s_waitcnt vmcnt(9)
    v_mfma_f32_16x16x32_bf16 v[128:131], a[224:227], v[88:91], v[128:131]
    ds_read_b64_tr_b16 a[224:225], v4 offset:50176
    ds_read_b64_tr_b16 a[226:227], v4 offset:51200
    v_mfma_f32_16x16x32_bf16 v[132:135], a[228:231], v[88:91], v[132:135]
    ds_read_b64_tr_b16 a[228:229], v5 offset:50176
    ds_read_b64_tr_b16 a[230:231], v5 offset:51200
    s_add_u32 s79, s59, 0
    s_and_b32 s79, s79, 3
    s_mul_i32 s76, s79, 4224
    s_add_u32 m0, s73, s76
    s_lshl_b32 s79, s79, 14
    s_add_u32 s76, s77, s79
    v_mfma_f32_16x16x32_bf16 v[136:139], a[232:235], v[88:91], v[136:139]
    ds_read_b64_tr_b16 a[232:233], v6 offset:50176
    ds_read_b64_tr_b16 a[234:235], v6 offset:51200
    v_mfma_f32_16x16x32_bf16 v[140:143], a[236:239], v[88:91], v[140:143]
    buffer_load_dwordx4 v228, s[24:27], s76 offen lds
    ds_read_b64_tr_b16 a[236:237], v7 offset:50176
    ds_read_b64_tr_b16 a[238:239], v7 offset:51200
    s_waitcnt vmcnt(9)
    v_mfma_f32_16x16x32_bf16 v[128:131], a[240:243], v[92:95], v[128:131]
    buffer_load_dwordx4 v229, s[24:27], s76 offen offset:1056 lds
    ds_read_b64_tr_b16 a[240:241], v6 offset:53760
    ds_read_b64_tr_b16 a[242:243], v6 offset:54784
    v_mfma_f32_16x16x32_bf16 v[132:135], a[244:247], v[92:95], v[132:135]
    ds_read_b64_tr_b16 a[244:245], v7 offset:53760
    ds_read_b64_tr_b16 a[246:247], v7 offset:54784
    v_mfma_f32_16x16x32_bf16 v[136:139], a[248:251], v[92:95], v[136:139]
    buffer_load_dwordx4 v230, s[24:27], s76 offen offset:2112 lds
    ds_read_b64_tr_b16 a[248:249], v4 offset:53760
    ds_read_b64_tr_b16 a[250:251], v4 offset:54784
    v_mfma_f32_16x16x32_bf16 v[140:143], a[252:255], v[92:95], v[140:143]
    ds_read_b64_tr_b16 a[252:253], v5 offset:53760
    ds_read_b64_tr_b16 a[254:255], v5 offset:54784
    s_waitcnt vmcnt(10)
    v_mfma_f32_16x16x32_bf16 v[128:131], a[128:131], v[96:99], v[128:131]
    buffer_load_dwordx4 v231, s[24:27], s76 offen offset:3168 lds
    v_mfma_f32_16x16x32_bf16 v[132:135], a[132:135], v[96:99], v[132:135]
    v_mfma_f32_16x16x32_bf16 v[136:139], a[136:139], v[96:99], v[136:139]
    s_add_u32 s79, s59, 1
    s_and_b32 s79, s79, 3
    s_mul_i32 s76, s79, 4224
    s_add_u32 m0, s73, s76
    s_lshl_b32 s79, s79, 14
    s_add_u32 s76, s77, s79
    v_mfma_f32_16x16x32_bf16 v[140:143], a[140:143], v[96:99], v[140:143]
    buffer_load_dwordx4 v228, s[24:27], s76 offen lds
    s_waitcnt vmcnt(11)
    v_mfma_f32_16x16x32_bf16 v[128:131], a[144:147], v[100:103], v[128:131]
    v_mfma_f32_16x16x32_bf16 v[132:135], a[148:151], v[100:103], v[132:135]
    buffer_load_dwordx4 v229, s[24:27], s76 offen offset:1056 lds
    v_mfma_f32_16x16x32_bf16 v[136:139], a[152:155], v[100:103], v[136:139]
    v_mfma_f32_16x16x32_bf16 v[140:143], a[156:159], v[100:103], v[140:143]
    buffer_load_dwordx4 v230, s[24:27], s76 offen offset:2112 lds
    s_waitcnt vmcnt(12)
    v_mfma_f32_16x16x32_bf16 v[128:131], a[160:163], v[104:107], v[128:131]
    v_mfma_f32_16x16x32_bf16 v[132:135], a[164:167], v[104:107], v[132:135]
    buffer_load_dwordx4 v231, s[24:27], s76 offen offset:3168 lds
    v_mfma_f32_16x16x32_bf16 v[136:139], a[168:171], v[104:107], v[136:139]
    s_add_u32 s79, s59, 2
    s_and_b32 s79, s79, 3
    s_mul_i32 s76, s79, 4224
    s_add_u32 m0, s73, s76
    s_lshl_b32 s79, s79, 14
    s_add_u32 s76, s77, s79
    v_mfma_f32_16x16x32_bf16 v[140:143], a[172:175], v[104:107], v[140:143]
    s_waitcnt lgkmcnt(15)
    s_waitcnt vmcnt(12)
    v_mfma_f32_16x16x32_bf16 v[128:131], a[176:179], v[108:111], v[128:131]
    buffer_load_dwordx4 v228, s[24:27], s76 offen lds
    v_mfma_f32_16x16x32_bf16 v[132:135], a[180:183], v[108:111], v[132:135]
    v_mfma_f32_16x16x32_bf16 v[136:139], a[184:187], v[108:111], v[136:139]
    buffer_load_dwordx4 v229, s[24:27], s76 offen offset:1056 lds
    v_mfma_f32_16x16x32_bf16 v[140:143], a[188:191], v[108:111], v[140:143]
    s_waitcnt vmcnt(13)
    v_mfma_f32_16x16x32_bf16 v[128:131], a[192:195], v[112:115], v[128:131]
    buffer_load_dwordx4 v230, s[24:27], s76 offen offset:2112 lds
    v_mfma_f32_16x16x32_bf16 v[132:135], a[196:199], v[112:115], v[132:135]
    buffer_load_dwordx4 v231, s[24:27], s76 offen offset:3168 lds
    v_mfma_f32_16x16x32_bf16 v[136:139], a[200:203], v[112:115], v[136:139]
    v_mfma_f32_16x16x32_bf16 v[140:143], a[204:207], v[112:115], v[140:143]
    s_add_u32 s79, s59, 3
    s_and_b32 s79, s79, 3
    s_mul_i32 s76, s79, 4224
    s_add_u32 m0, s73, s76
    s_lshl_b32 s79, s79, 14
    s_add_u32 s76, s77, s79
    s_waitcnt vmcnt(14)
    v_mfma_f32_16x16x32_bf16 v[128:131], a[208:211], v[116:119], v[128:131]
    v_mfma_f32_16x16x32_bf16 v[132:135], a[212:215], v[116:119], v[132:135]
    buffer_load_dwordx4 v228, s[24:27], s76 offen lds
    v_mfma_f32_16x16x32_bf16 v[136:139], a[216:219], v[116:119], v[136:139]
    v_mfma_f32_16x16x32_bf16 v[140:143], a[220:223], v[116:119], v[140:143]
    buffer_load_dwordx4 v229, s[24:27], s76 offen offset:1056 lds
    s_waitcnt lgkmcnt(8)
    s_waitcnt vmcnt(15)
    v_mfma_f32_16x16x32_bf16 v[128:131], a[224:227], v[120:123], v[128:131]
    buffer_load_dwordx4 v230, s[24:27], s76 offen offset:2112 lds
    v_mfma_f32_16x16x32_bf16 v[132:135], a[228:231], v[120:123], v[132:135]
    v_mfma_f32_16x16x32_bf16 v[136:139], a[232:235], v[120:123], v[136:139]
    buffer_load_dwordx4 v231, s[24:27], s76 offen offset:3168 lds
    v_mfma_f32_16x16x32_bf16 v[140:143], a[236:239], v[120:123], v[140:143]
    s_waitcnt lgkmcnt(0)
    s_waitcnt vmcnt(16)
    v_mfma_f32_16x16x32_bf16 v[128:131], a[240:243], v[124:127], v[128:131]
    v_mfma_f32_16x16x32_bf16 v[132:135], a[244:247], v[124:127], v[132:135]
    v_mfma_f32_16x16x32_bf16 v[136:139], a[248:251], v[124:127], v[136:139]
    v_mfma_f32_16x16x32_bf16 v[140:143], a[252:255], v[124:127], v[140:143]
    v_mov_b32 v16, 0
    v_mov_b32_e64 v17, 0
    s_nop 2
    v_pk_fma_f32 v[192:193], v[128:129], v[144:145], v[192:193]
    v_cvt_pk_bf16_f32 v248, v192, v193
    v_pk_fma_f32 v[194:195], v[130:131], v[146:147], v[194:195]
    v_cvt_pk_bf16_f32 v249, v194, v195
    v_pk_fma_f32 v[196:197], v[132:133], v[148:149], v[196:197]
    v_cvt_pk_bf16_f32 v250, v196, v197
    v_pk_fma_f32 v[198:199], v[134:135], v[150:151], v[198:199]
    v_cvt_pk_bf16_f32 v251, v198, v199
    v_permlane16_swap_b32 v248, v250
    s_nop 0
    v_permlane16_swap_b32 v249, v251
    buffer_store_dwordx4 v[248:251], v14, s[48:51], s69 offen offset:0 sc1
    v_pk_fma_f32 v[200:201], v[136:137], v[152:153], v[200:201]
    v_cvt_pk_bf16_f32 v252, v200, v201
    v_pk_fma_f32 v[202:203], v[138:139], v[154:155], v[202:203]
    v_cvt_pk_bf16_f32 v253, v202, v203
    v_pk_fma_f32 v[204:205], v[140:141], v[156:157], v[204:205]
    v_cvt_pk_bf16_f32 v254, v204, v205
    v_pk_fma_f32 v[206:207], v[142:143], v[158:159], v[206:207]
    v_cvt_pk_bf16_f32 v255, v206, v207
    v_permlane16_swap_b32 v252, v254
    s_nop 0
    v_permlane16_swap_b32 v253, v255
    buffer_store_dwordx4 v[252:255], v14, s[48:51], s69 offen offset:2048 sc1
    v_dot2c_f32_bf16 v16, s71, v248
    v_dot2c_f32_bf16 v17, v248, v248
    v_dot2c_f32_bf16 v16, s71, v249
    v_dot2c_f32_bf16 v17, v249, v249
    v_dot2c_f32_bf16 v16, s71, v250
    v_dot2c_f32_bf16 v17, v250, v250
    v_dot2c_f32_bf16 v16, s71, v251
    v_dot2c_f32_bf16 v17, v251, v251
    v_dot2c_f32_bf16 v16, s71, v252
    v_dot2c_f32_bf16 v17, v252, v252
    v_dot2c_f32_bf16 v16, s71, v253
    v_dot2c_f32_bf16 v17, v253, v253
    v_dot2c_f32_bf16 v16, s71, v254
    v_dot2c_f32_bf16 v17, v254, v254
    v_dot2c_f32_bf16 v16, s71, v255
    v_dot2c_f32_bf16 v17, v255, v255
    s_nop 2
    v_permlane32_swap_b32 v16, v17
    v_add_f32 v16, v16, v17
    v_mov_b32 v17, v16
    s_nop 1
    v_permlane16_swap_b32 v16, v17
    v_add_f32 v16, v16, v17
    s_mov_b32 exec_lo, 0xffff
    s_mov_b32 exec_hi, 0xffff
    buffer_store_dword v16, v15, s[48:51], s70 offen sc1
    s_mov_b64 exec, -1
    s_barrier
    v_and_b32_e64 v4, 0x13, v0
    s_add_u32 m0, s89, 0
    s_add_u32 s76, s88, 860160
    v_bfe_u32 v56, v0, 2, 1
    v_lshl_add_u32 v4, v56, 3, v4
    buffer_load_dwordx4 v1, s[48:51], s76 offen sc1 lds
    v_bfe_u32 v56, v0, 3, 1
    v_lshl_add_u32 v4, v56, 2, v4
    v_lshrrev_b32 v56, 5, v0
    buffer_load_dwordx4 v1, s[48:51], s76 offen offset:1024 sc1 lds
    v_lshlrev_b32 v5, 4, v4
    v_lshl_add_u32 v5, v56, 9, v5
    v_lshlrev_b32 v57, 3, v4
    buffer_load_dwordx4 v1, s[48:51], s76 offen offset:2048 sc1 lds
    v_lshl_add_u32 v57, v56, 14, v57
    v_lshl_add_u32 v58, v56, 30, v57
    s_lshl_b32 s64, s52, 9
    buffer_load_dwordx4 v1, s[48:51], s76 offen offset:3072 sc1 lds
    s_add_u32 s64, s64, 159744
    v_and_b32_e64 v59, 31, v0
    v_lshl_add_u32 v6, v59, 2, s64
    s_add_u32 m0, s89, 4096
    s_add_u32 s76, s88, 864256
    v_lshl_add_u32 v7, v56, 4, s64
    v_add_u32 v11, 92160, v1
    buffer_load_dwordx4 v1, s[48:51], s76 offen sc1 lds
    s_lshl2_add_u32 s81, s56, s52
    s_lshl_b32 s66, s81, 7
    s_add_u32 s66, s66, 802816
    buffer_load_dwordx4 v1, s[48:51], s76 offen offset:1024 sc1 lds
    s_mul_i32 s65, s81, 28672
    s_add_u32 s65, s65, 4194304
    s_lshl_b32 s67, s81, 8
    buffer_load_dwordx4 v1, s[48:51], s76 offen offset:2048 sc1 lds
    s_add_u32 s67, s67, 131072
    v_mov_b32 v240, v1
    v_add_u32 v241, 3040, v240
    buffer_load_dwordx4 v1, s[48:51], s76 offen offset:3072 sc1 lds
    v_add_u32 v242, 6080, v240
    v_add_u32 v243, 9120, v240
    s_waitcnt vmcnt(8)
    s_mov_b64 exec, 1
    buffer_atomic_add v3, off, s[48:51], s75 sc1
    s_mov_b64 exec, -1
    s_add_u32 m0, s89, 8192
    s_add_u32 s76, s88, 868352
    buffer_load_dwordx4 v1, s[48:51], s76 offen sc1 lds
    buffer_load_dwordx4 v1, s[48:51], s76 offen offset:1024 sc1 lds
    buffer_load_dwordx4 v1, s[48:51], s76 offen offset:2048 sc1 lds
    buffer_load_dwordx4 v1, s[48:51], s76 offen offset:3072 sc1 lds
    s_add_u32 m0, s89, 12288
    s_add_u32 s76, s88, 872448
    buffer_load_dwordx4 v1, s[48:51], s76 offen sc1 lds
    buffer_load_dwordx4 v1, s[48:51], s76 offen offset:1024 sc1 lds
    buffer_load_dwordx4 v1, s[48:51], s76 offen offset:2048 sc1 lds
    v_and_b32 v16, 15, v0
    v_mul_u32_u24 v16, 1056, v16
    v_and_b32_e64 v17, 48, v0
    v_add3_u32 v16, v16, v17, s73
    ds_read_b128 a[128:131], v16 offset:0
    ds_read_b128 a[132:135], v16 offset:64
    ds_read_b128 a[136:139], v16 offset:128
    ds_read_b128 a[140:143], v16 offset:192
    ds_read_b128 a[144:147], v16 offset:256
    ds_read_b128 a[148:151], v16 offset:320
    ds_read_b128 a[152:155], v16 offset:384
    ds_read_b128 a[156:159], v16 offset:448
    ds_read_b128 a[160:163], v16 offset:512
    ds_read_b128 a[164:167], v16 offset:576
    ds_read_b128 a[168:171], v16 offset:640
    ds_read_b128 a[172:175], v16 offset:704
    ds_read_b128 a[176:179], v16 offset:768
    ds_read_b128 a[180:183], v16 offset:832
    ds_read_b128 a[184:187], v16 offset:896
    ds_read_b128 a[188:191], v16 offset:960
    s_sub_u32 s73, s73, 92160
    s_mul_i32 s78, s53, 14
    s_mov_b64 exec, 1
    s_mov_b32 s72, 524288
L_poll3:
    v_mov_b32 v60, 0
    buffer_atomic_add v60, off, s[48:51], s66 sc0 sc1
    s_sub_u32 s72, s72, 1
    s_cbranch_scc1 L_pollx3
    s_waitcnt vmcnt(0)
    v_cmp_ne_u32 vcc, s78, v60
    s_nop 0
    s_cbranch_vccnz L_poll3
L_pollx3:
    s_mov_b64 exec, -1
    buffer_load_dwordx4 v[64:67], v5, s[48:51], s65 offen offset:0 sc1
    buffer_load_dwordx4 v[68:71], v5, s[48:51], s65 offen offset:1024 sc1
    buffer_load_dwordx4 v[72:75], v5, s[48:51], s65 offen offset:2048 sc1
    buffer_load_dwordx4 v[76:79], v5, s[48:51], s65 offen offset:3072 sc1
    s_waitcnt lgkmcnt(0)
    s_barrier
    ds_read_b128 a[192:195], v1 offset:0
    ds_read_b128 a[196:199], v1 offset:30720
    ds_read_b128 a[200:203], v1 offset:1024
    ds_read_b128 a[204:207], v1 offset:31744
    ds_read_b128 a[208:211], v1 offset:2048
    s_add_u32 s65, s65, 4096
    buffer_load_dwordx4 v[80:83], v5, s[48:51], s65 offen offset:0 sc1
    buffer_load_dwordx4 v[84:87], v5, s[48:51], s65 offen offset:1024 sc1
    buffer_load_dwordx4 v[88:91], v5, s[48:51], s65 offen offset:2048 sc1
    buffer_load_dwordx2 v[40:41], v57, s[48:51], s67 offen sc1
    s_add_u32 s67, s67, 32768
    buffer_load_dwordx2 v[42:43], v57, s[48:51], s67 offen sc1
    s_add_u32 s67, s67, 32768
    buffer_load_dwordx2 v[44:45], v57, s[48:51], s67 offen sc1
    s_add_u32 s67, s67, 32768
    buffer_load_dwordx2 v[46:47], v58, s[48:51], s67 offen sc1
    s_mul_i32 s18, s59, 112
    s_add_u32 s19, s18, 111
    s_lshr_b32 s18, s18, 6
    s_lshr_b32 s19, s19, 6
    s_sub_u32 s22, s19, s18
    s_lshl2_add_u32 s22, s22, 4
    s_mul_i32 s22, s22, s53
    s_and_b32 s20, s58, 3
    s_lshl2_add_u32 s10, s59, s52
    s_lshl2_add_u32 s10, s10, s20
    s_lshl_b32 s10, s10, 7
    s_add_u32 s10, s10, 827392
    v_and_b32 v15, 15, v0
    s_lshl2_add_u32 s4, s58, s52
    v_lshlrev_b32 v15, 1, v15
    s_lshl_b32 s17, s4, 5
    s_and_b32 s5, s59, 1
    s_mul_i32 s18, s59, 7
    s_add_u32 s19, s18, s5
    s_xor_b32 s20, s5, 1
    s_mul_i32 s20, s20, 6
    s_add_u32 s18, s18, s20
    s_mul_i32 s20, s52, 16384
    s_add_u32 s20, s20, 8388608
    s_mul_i32 s6, s19, 65536
    s_add_u32 s6, s6, s20
    s_mul_i32 s7, s18, 65536
    s_add_u32 s7, s7, s20
    s_mul_i32 s20, s4, 28672
    s_lshr_b32 s19, s19, 1
    s_lshl_b32 s19, s19, 10
    s_add_u32 s8, s19, s20
    s_lshr_b32 s18, s18, 1
    s_lshl_b32 s18, s18, 10
    s_add_u32 s9, s18, s20
    s_lshl_b32 s18, s5, 3
    s_add_u32 s9, s9, s18
    s_lshl_b32 s16, s4, 7
    s_add_u32 s16, s16, 811008
    s_lshr_b32 s11, s4, 1
    s_lshl_b32 s11, s11, 7
    s_add_u32 s11, s11, 872448
    s_mul_i32 s36, s52, 3072
    s_add_u32 s36, s36, 67584
    s_add_u32 s37, s52, 1
    s_and_b32 s37, s37, 3
    s_mul_i32 s37, s37, 3072
    s_add_u32 s37, s37, 67584
    s_add_u32 s38, s52, 2
    s_and_b32 s38, s38, 3
    s_mul_i32 s38, s38, 3072
    s_add_u32 s38, s38, 68608
    s_add_u32 s39, s52, 3
    s_and_b32 s39, s39, 3
    s_mul_i32 s39, s39, 3072
    s_add_u32 s39, s39, 69632
    s_waitcnt vmcnt(10) lgkmcnt(3)
    v_mfma_f32_32x32x16_bf16 v[176:191], v[64:67], a[192:195], 0
    buffer_load_dwordx4 v[92:95], v5, s[48:51], s65 offen offset:3072 sc1
    ds_read_b128 a[212:215], v1 offset:32768
    s_add_u32 s65, s65, 4096
    buffer_load_dwordx4 v[96:99], v5, s[48:51], s65 offen offset:0 sc1
    buffer_load_dwordx4 v[100:103], v5, s[48:51], s65 offen offset:1024 sc1
    v_mfma_f32_32x32x16_bf16 v[192:207], v[64:67], a[196:199], 0
    ds_read_b128 a[216:219], v1 offset:3072
    s_waitcnt vmcnt(12) lgkmcnt(3)
    v_mfma_f32_32x32x16_bf16 v[176:191], v[68:71], a[200:203], v[176:191]
    buffer_load_dwordx4 v[104:107], v5, s[48:51], s65 offen offset:2048 sc1
    ds_read_b128 a[220:223], v1 offset:33792
    v_mfma_f32_32x32x16_bf16 v[192:207], v[68:71], a[204:207], v[192:207]
    ds_read_b128 a[192:195], v1 offset:4096
    s_waitcnt vmcnt(12) lgkmcnt(3)
    v_mfma_f32_32x32x16_bf16 v[176:191], v[72:75], a[208:211], v[176:191]
    buffer_load_dwordx4 v[108:111], v5, s[48:51], s65 offen offset:3072 sc1
    ds_read_b128 a[196:199], v1 offset:34816
    v_mfma_f32_32x32x16_bf16 v[192:207], v[72:75], a[212:215], v[192:207]
    ds_read_b128 a[200:203], v1 offset:5120
    s_waitcnt vmcnt(12) lgkmcnt(3)
    v_mfma_f32_32x32x16_bf16 v[176:191], v[76:79], a[216:219], v[176:191]
    ds_read_b128 a[204:207], v1 offset:35840
    s_add_u32 s65, s65, 4096
    buffer_load_dwordx4 v[112:115], v5, s[48:51], s65 offen offset:0 sc1
    v_mfma_f32_32x32x16_bf16 v[192:207], v[76:79], a[220:223], v[192:207]
    ds_read_b128 a[208:211], v1 offset:6144
    s_waitcnt vmcnt(12) lgkmcnt(3)
    v_mfma_f32_32x32x16_bf16 v[176:191], v[80:83], a[192:195], v[176:191]
    buffer_load_dwordx4 v[116:119], v5, s[48:51], s65 offen offset:1024 sc1
    ds_read_b128 a[212:215], v1 offset:36864
    v_mfma_f32_32x32x16_bf16 v[192:207], v[80:83], a[196:199], v[192:207]
    ds_read_b128 a[216:219], v1 offset:7168
    s_waitcnt vmcnt(12) lgkmcnt(3)
    v_mfma_f32_32x32x16_bf16 v[176:191], v[84:87], a[200:203], v[176:191]
    buffer_load_dwordx4 v[120:123], v5, s[48:51], s65 offen offset:2048 sc1
    ds_read_b128 a[220:223], v1 offset:37888
    v_mfma_f32_32x32x16_bf16 v[192:207], v[84:87], a[204:207], v[192:207]
    ds_read_b128 a[192:195], v1 offset:8192
    s_waitcnt vmcnt(12) lgkmcnt(3)
    v_mfma_f32_32x32x16_bf16 v[176:191], v[88:91], a[208:211], v[176:191]
    buffer_load_dwordx4 v[124:127], v5, s[48:51], s65 offen offset:3072 sc1
    ds_read_b128 a[196:199], v1 offset:38912
    v_mfma_f32_32x32x16_bf16 v[192:207], v[88:91], a[212:215], v[192:207]
    ds_read_b128 a[200:203], v1 offset:9216
    s_waitcnt vmcnt(8) lgkmcnt(3)
    v_mfma_f32_32x32x16_bf16 v[176:191], v[92:95], a[216:219], v[176:191]
    ds_read_b128 a[204:207], v1 offset:39936
    s_add_u32 s65, s65, 4096
    buffer_load_dwordx4 v[128:131], v5, s[48:51], s65 offen offset:0 sc1
    v_mfma_f32_32x32x16_bf16 v[192:207], v[92:95], a[220:223], v[192:207]
    ds_read_b128 a[208:211], v1 offset:10240
    s_waitcnt vmcnt(8) lgkmcnt(3)
    v_mfma_f32_32x32x16_bf16 v[176:191], v[96:99], a[192:195], v[176:191]
    buffer_load_dwordx4 v[132:135], v5, s[48:51], s65 offen offset:1024 sc1
    ds_read_b128 a[212:215], v1 offset:40960
    v_add_f32 v40, v40, v42
    v_add_f32 v41, v41, v43
    v_mfma_f32_32x32x16_bf16 v[192:207], v[96:99], a[196:199], v[192:207]
    ds_read_b128 a[216:219], v1 offset:11264
    v_add_f32 v44, v44, v46
    v_add_f32 v45, v45, v47
    s_waitcnt vmcnt(8) lgkmcnt(3)
    v_mfma_f32_32x32x16_bf16 v[176:191], v[100:103], a[200:203], v[176:191]
    buffer_load_dwordx4 v[136:139], v5, s[48:51], s65 offen offset:2048 sc1
    ds_read_b128 a[220:223], v1 offset:41984
    v_add_f32 v40, v40, v44
    v_add_f32 v41, v41, v45
    v_mfma_f32_32x32x16_bf16 v[192:207], v[100:103], a[204:207], v[192:207]
    ds_read_b128 a[192:195], v1 offset:12288
    v_permlane32_swap_b32 v40, v41
    v_add_f32_e64 v40, v40, v41
    s_waitcnt vmcnt(8) lgkmcnt(3)
    v_mfma_f32_32x32x16_bf16 v[176:191], v[104:107], a[208:211], v[176:191]
    buffer_load_dwordx4 v[140:143], v5, s[48:51], s65 offen offset:3072 sc1
    ds_read_b128 a[196:199], v1 offset:43008
    v_mul_f32 v40, 0x3b124925, v40
    v_mfma_f32_32x32x16_bf16 v[192:207], v[104:107], a[212:215], v[192:207]
    ds_read_b128 a[200:203], v1 offset:13312
    v_mov_b32 v41, v40
    s_nop 1
    v_permlane32_swap_b32 v40, v41
    s_waitcnt vmcnt(8) lgkmcnt(3)
    v_mfma_f32_32x32x16_bf16 v[176:191], v[108:111], a[216:219], v[176:191]
    ds_read_b128 a[204:207], v1 offset:44032
    s_add_u32 s65, s65, 4096
    buffer_load_dwordx4 v[144:147], v5, s[48:51], s65 offen offset:0 sc1
    v_fma_f32 v10, -v40, v40, v41
    v_max_f32 v10, 0, v10
    v_mfma_f32_32x32x16_bf16 v[192:207], v[108:111], a[220:223], v[192:207]
    ds_read_b128 a[208:211], v1 offset:14336
    v_add_f32 v10, 0x3727c5ac, v10
    v_rsq_f32 v8, v10
    s_branch L_page4
.p2align 12
L_stub4:
    s_branch L_stub8
L_page4:
    s_waitcnt vmcnt(8) lgkmcnt(3)
    v_mfma_f32_32x32x16_bf16 v[176:191], v[112:115], a[192:195], v[176:191]
    buffer_load_dwordx4 v[148:151], v5, s[48:51], s65 offen offset:1024 sc1
    ds_read_b128 a[212:215], v1 offset:45056
    v_sub_f32 v40, 0, v40
    v_mul_f32 v9, v10, v8
    v_mfma_f32_32x32x16_bf16 v[192:207], v[112:115], a[196:199], v[192:207]
    ds_read_b128 a[216:219], v1 offset:15360
    v_mul_f32 v17, 0xc0135761, v8
    s_waitcnt vmcnt(8) lgkmcnt(3)
    v_mfma_f32_32x32x16_bf16 v[176:191], v[116:119], a[200:203], v[176:191]
    buffer_load_dwordx4 v[152:155], v5, s[48:51], s65 offen offset:2048 sc1
    ds_read_b128 a[220:223], v1 offset:46080
    v_mul_f32 v16, v8, v8
    v_mul_f32 v16, v16, v8
    v_mfma_f32_32x32x16_bf16 v[192:207], v[116:119], a[204:207], v[192:207]
    ds_read_b128 a[192:195], v1 offset:16384
    v_mul_f32 v16, 0xbdd2d3e8, v16
    v_mov_b32_e64 v41, v9
    s_waitcnt vmcnt(8) lgkmcnt(3)
    v_mfma_f32_32x32x16_bf16 v[176:191], v[120:123], a[208:211], v[176:191]
    buffer_load_dwordx4 v[156:159], v5, s[48:51], s65 offen offset:3072 sc1
    ds_read_b128 a[196:199], v1 offset:47104
    ds_write_b32 v6, v16
    ds_write_b32 v6, v17 offset:128
    v_mfma_f32_32x32x16_bf16 v[192:207], v[120:123], a[212:215], v[192:207]
    ds_read_b128 a[200:203], v1 offset:17408
    v_cvt_pk_bf16_f32 v20, v40, v41
    v_lshlrev_b32 v42, 16, v20
    s_waitcnt vmcnt(8) lgkmcnt(5)
    v_mfma_f32_32x32x16_bf16 v[176:191], v[124:127], a[216:219], v[176:191]
    ds_read_b128 a[204:207], v1 offset:48128
    s_add_u32 s65, s65, 4096
    buffer_load_dwordx4 v[160:163], v5, s[48:51], s65 offen offset:0 sc1
    v_sub_f32 v40, v40, v42
    v_mfma_f32_32x32x16_bf16 v[192:207], v[124:127], a[220:223], v[192:207]
    ds_read_b128 a[208:211], v1 offset:18432
    v_and_b32 v42, s74, v20
    v_sub_f32 v41, v41, v42
    s_waitcnt vmcnt(8) lgkmcnt(5)
    v_mfma_f32_32x32x16_bf16 v[176:191], v[128:131], a[192:195], v[176:191]
    buffer_load_dwordx4 v[164:167], v5, s[48:51], s65 offen offset:1024 sc1
    ds_read_b128 a[212:215], v1 offset:49152
    v_cvt_pk_bf16_f32 v21, v40, v41
    v_mov_b32 v22, v20
    v_mfma_f32_32x32x16_bf16 v[192:207], v[128:131], a[196:199], v[192:207]
    ds_read_b128 a[216:219], v1 offset:19456
    v_mov_b32_e64 v23, 0
    v_mul_f32 v10, 0x3727c5ac, v10
    s_waitcnt vmcnt(8) lgkmcnt(3)
    v_mfma_f32_32x32x16_bf16 v[176:191], v[132:135], a[200:203], v[176:191]
    buffer_load_dwordx4 v[168:171], v5, s[48:51], s65 offen offset:2048 sc1
    ds_read_b128 a[220:223], v1 offset:50176
    ds_read_b128 v[24:27], v7 offset:0
    v_mfma_f32_32x32x16_bf16 v[192:207], v[132:135], a[204:207], v[192:207]
    ds_read_b128 a[192:195], v1 offset:20480
    ds_read_b128 v[40:43], v7 offset:128
    ds_read_b128 v[28:31], v7 offset:32
    s_waitcnt vmcnt(8) lgkmcnt(6)
    v_mfma_f32_32x32x16_bf16 v[176:191], v[136:139], a[208:211], v[176:191]
    buffer_load_dwordx4 v[172:175], v5, s[48:51], s65 offen offset:3072 sc1
    ds_read_b128 a[196:199], v1 offset:51200
    ds_read_b128 v[44:47], v7 offset:160
    ds_read_b128 v[32:35], v7 offset:64
    v_mfma_f32_32x32x16_bf16 v[192:207], v[136:139], a[212:215], v[192:207]
    ds_read_b128 a[200:203], v1 offset:21504
    ds_read_b128 v[48:51], v7 offset:192
    ds_read_b128 v[36:39], v7 offset:96
    s_waitcnt vmcnt(8) lgkmcnt(10)
    v_mfma_f32_32x32x16_bf16 v[176:191], v[140:143], a[216:219], v[176:191]
    ds_read_b128 a[204:207], v1 offset:52224
    s_add_u32 m0, s89, 92160
    s_add_u32 s76, s88, 0
    ds_read_b128 v[52:55], v7 offset:224
    v_and_b32 v18, 0x11, v0
    v_mfma_f32_32x32x16_bf16 v[192:207], v[140:143], a[220:223], v[192:207]
    buffer_load_dwordx4 v1, s[48:51], s76 offen sc1 lds
    ds_read_b128 a[208:211], v1 offset:22528
    v_lshl_add_u32 v18, v56, 3, v18
    s_waitcnt vmcnt(8) lgkmcnt(8)
    v_mfma_f32_32x32x16_bf16 v[176:191], v[144:147], a[192:195], v[176:191]
    buffer_load_dwordx4 v1, s[48:51], s76 offen offset:1024 sc1 lds
    ds_read_b128 a[212:215], v1 offset:53248
    v_bfe_u32 v57, v0, 2, 2
    v_lshl_add_u32 v18, v57, 1, v18
    v_mfma_f32_32x32x16_bf16 v[192:207], v[144:147], a[196:199], v[192:207]
    buffer_load_dwordx4 v1, s[48:51], s76 offen offset:2048 sc1 lds
    ds_read_b128 a[216:219], v1 offset:23552
    v_lshlrev_b32 v18, 4, v18
    v_lshlrev_b32 v19, 4, v4
    s_waitcnt vmcnt(9) lgkmcnt(4)
    v_mfma_f32_32x32x16_bf16 v[176:191], v[148:151], a[200:203], v[176:191]
    buffer_load_dwordx4 v1, s[48:51], s76 offen offset:3072 sc1 lds
    ds_read_b128 a[220:223], v1 offset:54272
    v_lshl_add_u32 v19, v56, 15, v19
    v_bfe_u32 v244, v0, 4, 1
    v_mfma_f32_32x32x16_bf16 v[192:207], v[148:151], a[204:207], v[192:207]
    ds_read_b128 a[192:195], v1 offset:24576
    s_add_u32 m0, s89, 96256
    s_add_u32 s76, s88, 4096
    v_mul_u32_u24 v244, 65536, v244
    v_lshl_add_u32 v244, v56, 8, v244
    s_waitcnt vmcnt(9) lgkmcnt(3)
    v_mfma_f32_32x32x16_bf16 v[176:191], v[152:155], a[208:211], v[176:191]
    buffer_load_dwordx4 v1, s[48:51], s76 offen sc1 lds
    ds_read_b128 a[196:199], v1 offset:55296
    v_and_b32 v57, 15, v0
    v_mfma_f32_32x32x16_bf16 v[192:207], v[152:155], a[212:215], v[192:207]
    buffer_load_dwordx4 v1, s[48:51], s76 offen offset:1024 sc1 lds
    ds_read_b128 a[200:203], v1 offset:25600
    v_lshl_add_u32 v244, v57, 4, v244
    v_lshrrev_b32 v245, 4, v4
    s_waitcnt vmcnt(10) lgkmcnt(3)
    v_mfma_f32_32x32x16_bf16 v[176:191], v[156:159], a[216:219], v[176:191]
    buffer_load_dwordx4 v1, s[48:51], s76 offen offset:2048 sc1 lds
    ds_read_b128 a[204:207], v1 offset:56320
    v_mul_u32_u24 v245, 28672, v245
    v_and_b32 v57, 15, v4
    v_mfma_f32_32x32x16_bf16 v[192:207], v[156:159], a[220:223], v[192:207]
    buffer_load_dwordx4 v1, s[48:51], s76 offen offset:3072 sc1 lds
    ds_read_b128 a[208:211], v1 offset:26624
    v_lshl_add_u32 v245, v57, 4, v245
    v_lshl_add_u32 v245, v56, 8, v245
    s_waitcnt vmcnt(11) lgkmcnt(3)
    v_mfma_f32_32x32x16_bf16 v[176:191], v[160:163], a[192:195], v[176:191]
    ds_read_b128 a[212:215], v1 offset:57344
    s_add_u32 m0, s89, 100352
    s_add_u32 s76, s88, 8192
    s_mul_i32 s84, s81, 57344
    s_lshl_b32 s64, s55, 11
    s_add_u32 s84, s84, s64
    s_add_u32 s84, s84, 12582912
    v_mfma_f32_32x32x16_bf16 v[192:207], v[160:163], a[196:199], v[192:207]
    buffer_load_dwordx4 v1, s[48:51], s76 offen sc1 lds
    ds_read_b128 a[216:219], v1 offset:27648
    s_mul_i32 s85, s55, 262144
    s_lshl_b32 s64, s81, 10
    s_waitcnt vmcnt(11) lgkmcnt(3)
    v_mfma_f32_32x32x16_bf16 v[176:191], v[164:167], a[200:203], v[176:191]
    buffer_load_dwordx4 v1, s[48:51], s76 offen offset:1024 sc1 lds
    ds_read_b128 a[220:223], v1 offset:58368
    s_add_u32 s85, s85, s64
    s_add_u32 s85, s85, 8388608
    s_lshr_b32 s64, s81, 4
    s_mul_i32 s64, s64, 0
    s_add_u32 s85, s85, s64
    v_mfma_f32_32x32x16_bf16 v[192:207], v[164:167], a[204:207], v[192:207]
    buffer_load_dwordx4 v1, s[48:51], s76 offen offset:2048 sc1 lds
    ds_read_b128 a[192:195], v1 offset:28672
    s_add_u32 s87, s85, 131072
    s_lshr_b32 s75, s81, 4
    s_lshl2_add_u32 s75, s75, s52
    s_lshl_b32 s75, s75, 7
    s_add_u32 s75, s75, 827392
    s_waitcnt vmcnt(12) lgkmcnt(3)
    v_mfma_f32_32x32x16_bf16 v[176:191], v[168:171], a[208:211], v[176:191]
    buffer_load_dwordx4 v1, s[48:51], s76 offen offset:3072 sc1 lds
    ds_read_b128 a[196:199], v1 offset:59392
    s_add_u32 s80, s66, 61440
    s_lshl_b32 s83, s81, 9
    s_add_u32 s83, s83, 262144
    v_mfma_f32_32x32x16_bf16 v[192:207], v[168:171], a[212:215], v[192:207]
    ds_read_b128 a[200:203], v1 offset:29696
    s_add_u32 m0, s89, 104448
    s_add_u32 s76, s88, 12288
    s_lshl_b32 s71, s55, 15
    s_add_u32 s71, s71, s83
    s_waitcnt vmcnt(12) lgkmcnt(3)
    v_mfma_f32_32x32x16_bf16 v[176:191], v[172:175], a[216:219], v[176:191]
    buffer_load_dwordx4 v1, s[48:51], s76 offen sc1 lds
    ds_read_b128 a[204:207], v1 offset:60416
    v_mfma_f32_32x32x16_bf16 v[192:207], v[172:175], a[220:223], v[192:207]
    buffer_load_dwordx4 v1, s[48:51], s76 offen offset:1024 sc1 lds
    s_waitcnt lgkmcnt(2)
    v_mfma_f32_32x32x16_bf16 v[176:191], v[20:23], a[192:195], v[176:191]
    buffer_load_dwordx4 v1, s[48:51], s76 offen offset:2048 sc1 lds
    v_mfma_f32_32x32x16_bf16 v[192:207], v[20:23], a[196:199], v[192:207]
    s_waitcnt lgkmcnt(0)
    v_mfma_f32_32x32x16_bf16 v[176:191], v[20:23], a[200:203], v[176:191]
    v_mfma_f32_32x32x16_bf16 v[192:207], v[20:23], a[204:207], v[192:207]
    s_mov_b32 vcc_lo, 0xaaaaaaaa
    s_mov_b32 vcc_hi, 0xaaaaaaaa
    s_barrier
    s_nop 7
    v_pk_mul_f32 v[60:61], v[176:177], v[176:177]
    v_pk_mul_f32 v[62:63], v[192:193], v[192:193]
    v_pk_fma_f32 v[60:61], v[60:61], v[24:25], v[40:41]
    v_pk_fma_f32 v[62:63], v[62:63], v[24:25], v[40:41]
    v_pk_mul_f32 v[60:61], v[60:61], v[176:177]
    v_pk_mul_f32 v[62:63], v[62:63], v[192:193]
    v_exp_f32 v60, v60
    v_exp_f32 v61, v61
    v_exp_f32 v62, v62
    v_exp_f32 v63, v63
    v_pk_add_f32 v[60:61], v[60:61], 1.0 op_sel_hi:[1,0]
    v_pk_add_f32 v[62:63], v[62:63], 1.0 op_sel_hi:[1,0]
    v_rcp_f32 v60, v60
    v_rcp_f32 v61, v61
    v_rcp_f32 v62, v62
    v_rcp_f32 v63, v63
    v_pk_mul_f32 v[176:177], v[176:177], v[60:61]
    v_pk_mul_f32 v[192:193], v[192:193], v[62:63]
    v_pk_add_f32 v[24:25], v[176:177], v[192:193]
    v_pk_mul_f32 v[40:41], v[176:177], v[176:177]
    v_pk_fma_f32 v[40:41], v[192:193], v[192:193], v[40:41]
    v_pk_mul_f32 v[60:61], v[178:179], v[178:179]
    v_pk_mul_f32 v[62:63], v[194:195], v[194:195]
    v_pk_fma_f32 v[60:61], v[60:61], v[26:27], v[42:43]
    v_pk_fma_f32 v[62:63], v[62:63], v[26:27], v[42:43]
    v_pk_mul_f32 v[60:61], v[60:61], v[178:179]
    v_pk_mul_f32 v[62:63], v[62:63], v[194:195]
    v_exp_f32 v60, v60
    v_exp_f32 v61, v61
    v_exp_f32 v62, v62
    v_exp_f32 v63, v63
    v_pk_add_f32 v[60:61], v[60:61], 1.0 op_sel_hi:[1,0]
    v_pk_add_f32 v[62:63], v[62:63], 1.0 op_sel_hi:[1,0]
    v_rcp_f32 v60, v60
    v_rcp_f32 v61, v61
    v_rcp_f32 v62, v62
    v_rcp_f32 v63, v63
    v_pk_mul_f32 v[178:179], v[178:179], v[60:61]
    v_pk_mul_f32 v[194:195], v[194:195], v[62:63]
    v_pk_add_f32 v[26:27], v[178:179], v[194:195]
    v_pk_mul_f32 v[42:43], v[178:179], v[178:179]
    s_add_u32 s77, s52, 3
    s_and_b32 s77, s77, 3
    v_pk_fma_f32 v[42:43], v[194:195], v[194:195], v[42:43]
    v_pk_mul_f32 v[60:61], v[180:181], v[180:181]
    v_pk_mul_f32 v[62:63], v[196:197], v[196:197]
    v_pk_fma_f32 v[60:61], v[60:61], v[28:29], v[44:45]
    v_pk_fma_f32 v[62:63], v[62:63], v[28:29], v[44:45]
    v_pk_mul_f32 v[60:61], v[60:61], v[180:181]
    v_pk_mul_f32 v[62:63], v[62:63], v[196:197]
    v_exp_f32 v60, v60
    v_exp_f32 v61, v61
    v_exp_f32 v62, v62
    s_lshl_b32 s77, s77, 16
    s_add_u32 s77, s77, s86
    v_exp_f32 v63, v63
    v_pk_add_f32 v[60:61], v[60:61], 1.0 op_sel_hi:[1,0]
    v_pk_add_f32 v[62:63], v[62:63], 1.0 op_sel_hi:[1,0]
    v_rcp_f32 v60, v60
    v_rcp_f32 v61, v61
    v_rcp_f32 v62, v62
    v_rcp_f32 v63, v63
    v_pk_mul_f32 v[180:181], v[180:181], v[60:61]
    v_pk_mul_f32 v[196:197], v[196:197], v[62:63]
    v_pk_add_f32 v[28:29], v[180:181], v[196:197]
    s_add_u32 m0, s73, 0
    s_add_u32 s76, s77, 0
    v_pk_mul_f32 v[44:45], v[180:181], v[180:181]
    v_pk_fma_f32 v[44:45], v[196:197], v[196:197], v[44:45]
    v_pk_mul_f32 v[60:61], v[182:183], v[182:183]
    v_pk_mul_f32 v[62:63], v[198:199], v[198:199]
    v_pk_fma_f32 v[60:61], v[60:61], v[30:31], v[46:47]
    v_pk_fma_f32 v[62:63], v[62:63], v[30:31], v[46:47]
    v_pk_mul_f32 v[60:61], v[60:61], v[182:183]
    v_pk_mul_f32 v[62:63], v[62:63], v[198:199]
    v_exp_f32 v60, v60
    v_exp_f32 v61, v61
    v_exp_f32 v62, v62
    buffer_load_dwordx4 v240, s[24:27], s76 offen lds
    v_exp_f32 v63, v63
    v_pk_add_f32 v[60:61], v[60:61], 1.0 op_sel_hi:[1,0]
    v_pk_add_f32 v[62:63], v[62:63], 1.0 op_sel_hi:[1,0]
    v_rcp_f32 v60, v60
    v_rcp_f32 v61, v61
    v_rcp_f32 v62, v62
    v_rcp_f32 v63, v63
    v_pk_mul_f32 v[182:183], v[182:183], v[60:61]
    v_pk_mul_f32 v[198:199], v[198:199], v[62:63]
    v_pk_add_f32 v[30:31], v[182:183], v[198:199]
    buffer_load_dwordx4 v241, s[24:27], s76 offen offset:1056 lds
    v_pk_mul_f32 v[46:47], v[182:183], v[182:183]
    v_pk_fma_f32 v[46:47], v[198:199], v[198:199], v[46:47]
    v_pk_mul_f32 v[60:61], v[184:185], v[184:185]
    v_pk_mul_f32 v[62:63], v[200:201], v[200:201]
    v_pk_fma_f32 v[60:61], v[60:61], v[32:33], v[48:49]
    v_pk_fma_f32 v[62:63], v[62:63], v[32:33], v[48:49]
    v_pk_mul_f32 v[60:61], v[60:61], v[184:185]
    v_pk_mul_f32 v[62:63], v[62:63], v[200:201]
    v_exp_f32 v60, v60
    v_exp_f32 v61, v61
    v_exp_f32 v62, v62
    buffer_load_dwordx4 v242, s[24:27], s76 offen offset:2112 lds
    v_exp_f32 v63, v63
    v_pk_add_f32 v[60:61], v[60:61], 1.0 op_sel_hi:[1,0]
    v_pk_add_f32 v[62:63], v[62:63], 1.0 op_sel_hi:[1,0]
    v_rcp_f32 v60, v60
    v_rcp_f32 v61, v61
    v_rcp_f32 v62, v62
    v_rcp_f32 v63, v63
    v_pk_mul_f32 v[184:185], v[184:185], v[60:61]
    v_pk_mul_f32 v[200:201], v[200:201], v[62:63]
    v_pk_add_f32 v[32:33], v[184:185], v[200:201]
    buffer_load_dwordx4 v243, s[24:27], s76 offen offset:3168 lds
    v_pk_mul_f32 v[48:49], v[184:185], v[184:185]
    v_pk_fma_f32 v[48:49], v[200:201], v[200:201], v[48:49]
    v_pk_mul_f32 v[60:61], v[186:187], v[186:187]
    v_pk_mul_f32 v[62:63], v[202:203], v[202:203]
    v_pk_fma_f32 v[60:61], v[60:61], v[34:35], v[50:51]
    v_pk_fma_f32 v[62:63], v[62:63], v[34:35], v[50:51]
    v_pk_mul_f32 v[60:61], v[60:61], v[186:187]
    v_pk_mul_f32 v[62:63], v[62:63], v[202:203]
    v_exp_f32 v60, v60
    v_exp_f32 v61, v61
    s_add_u32 m0, s73, 4224
    s_add_u32 s76, s77, 16384
    v_exp_f32 v62, v62
    v_exp_f32 v63, v63
    v_pk_add_f32 v[60:61], v[60:61], 1.0 op_sel_hi:[1,0]
    v_pk_add_f32 v[62:63], v[62:63], 1.0 op_sel_hi:[1,0]
    v_rcp_f32 v60, v60
    v_rcp_f32 v61, v61
    v_rcp_f32 v62, v62
    v_rcp_f32 v63, v63
    v_pk_mul_f32 v[186:187], v[186:187], v[60:61]
    v_pk_mul_f32 v[202:203], v[202:203], v[62:63]
    v_pk_add_f32 v[34:35], v[186:187], v[202:203]
    buffer_load_dwordx4 v240, s[24:27], s76 offen lds
    v_pk_mul_f32 v[50:51], v[186:187], v[186:187]
    v_pk_fma_f32 v[50:51], v[202:203], v[202:203], v[50:51]
    v_pk_mul_f32 v[60:61], v[188:189], v[188:189]
    v_pk_mul_f32 v[62:63], v[204:205], v[204:205]
    v_pk_fma_f32 v[60:61], v[60:61], v[36:37], v[52:53]
    v_pk_fma_f32 v[62:63], v[62:63], v[36:37], v[52:53]
    v_pk_mul_f32 v[60:61], v[60:61], v[188:189]
    v_pk_mul_f32 v[62:63], v[62:63], v[204:205]
    v_exp_f32 v60, v60
    v_exp_f32 v61, v61
    buffer_load_dwordx4 v241, s[24:27], s76 offen offset:1056 lds
    v_exp_f32 v62, v62
    v_exp_f32 v63, v63
    v_pk_add_f32 v[60:61], v[60:61], 1.0 op_sel_hi:[1,0]
    v_pk_add_f32 v[62:63], v[62:63], 1.0 op_sel_hi:[1,0]
    v_rcp_f32 v60, v60
    v_rcp_f32 v61, v61
    v_rcp_f32 v62, v62
    v_rcp_f32 v63, v63
    v_pk_mul_f32 v[188:189], v[188:189], v[60:61]
    v_pk_mul_f32 v[204:205], v[204:205], v[62:63]
    v_pk_add_f32 v[36:37], v[188:189], v[204:205]
    buffer_load_dwordx4 v242, s[24:27], s76 offen offset:2112 lds
    v_pk_mul_f32 v[52:53], v[188:189], v[188:189]
    v_pk_fma_f32 v[52:53], v[204:205], v[204:205], v[52:53]
    v_pk_mul_f32 v[60:61], v[190:191], v[190:191]
    v_pk_mul_f32 v[62:63], v[206:207], v[206:207]
    v_pk_fma_f32 v[60:61], v[60:61], v[38:39], v[54:55]
    v_pk_fma_f32 v[62:63], v[62:63], v[38:39], v[54:55]
    v_pk_mul_f32 v[60:61], v[60:61], v[190:191]
    v_pk_mul_f32 v[62:63], v[62:63], v[206:207]
    v_exp_f32 v60, v60
    v_exp_f32 v61, v61
    buffer_load_dwordx4 v243, s[24:27], s76 offen offset:3168 lds
    v_exp_f32 v62, v62
    v_exp_f32 v63, v63
    v_pk_add_f32 v[60:61], v[60:61], 1.0 op_sel_hi:[1,0]
    v_pk_add_f32 v[62:63], v[62:63], 1.0 op_sel_hi:[1,0]
    v_rcp_f32 v60, v60
    v_rcp_f32 v61, v61
    v_rcp_f32 v62, v62
    v_rcp_f32 v63, v63
    v_pk_mul_f32 v[190:191], v[190:191], v[60:61]
    v_pk_mul_f32 v[206:207], v[206:207], v[62:63]
    v_pk_add_f32 v[38:39], v[190:191], v[206:207]
    v_pk_mul_f32 v[54:55], v[190:191], v[190:191]
    v_pk_fma_f32 v[54:55], v[206:207], v[206:207], v[54:55]
    v_permlane16_swap_b32 v24, v32
    v_permlane16_swap_b32 v25, v33
    v_permlane16_swap_b32 v40, v48
    v_permlane16_swap_b32 v41, v49
    v_pk_add_f32 v[24:25], v[24:25], v[32:33]
    v_pk_add_f32 v[40:41], v[40:41], v[48:49]
    v_permlane16_swap_b32 v26, v34
    v_permlane16_swap_b32 v27, v35
    v_permlane16_swap_b32 v42, v50
    v_permlane16_swap_b32 v43, v51
    v_pk_add_f32 v[26:27], v[26:27], v[34:35]
    v_pk_add_f32 v[42:43], v[42:43], v[50:51]
    v_permlane16_swap_b32 v28, v36
    v_permlane16_swap_b32 v29, v37
    v_permlane16_swap_b32 v44, v52
    v_permlane16_swap_b32 v45, v53
    v_pk_add_f32 v[28:29], v[28:29], v[36:37]
    v_pk_add_f32 v[44:45], v[44:45], v[52:53]
    v_permlane16_swap_b32 v30, v38
    v_permlane16_swap_b32 v31, v39
    v_permlane16_swap_b32 v46, v54
    v_permlane16_swap_b32 v47, v55
    v_pk_add_f32 v[30:31], v[30:31], v[38:39]
    v_pk_add_f32 v[46:47], v[46:47], v[54:55]
    v_add_f32_dpp v24, v24, v24 row_ror:8 row_mask:0xf bank_mask:0x3
    v_add_f32_dpp v40, v40, v40 row_ror:8 row_mask:0xf bank_mask:0x3
    v_add_f32_dpp v25, v25, v25 row_ror:8 row_mask:0xf bank_mask:0x3
    v_add_f32_dpp v41, v41, v41 row_ror:8 row_mask:0xf bank_mask:0x3
    v_add_f32_dpp v26, v26, v26 row_ror:8 row_mask:0xf bank_mask:0x3
    v_add_f32_dpp v42, v42, v42 row_ror:8 row_mask:0xf bank_mask:0x3
    v_add_f32_dpp v27, v27, v27 row_ror:8 row_mask:0xf bank_mask:0x3
    v_add_f32_dpp v43, v43, v43 row_ror:8 row_mask:0xf bank_mask:0x3
    v_add_f32_dpp v24, v28, v28 row_ror:8 row_mask:0xf bank_mask:0xc
    v_add_f32_dpp v40, v44, v44 row_ror:8 row_mask:0xf bank_mask:0xc
    v_add_f32_dpp v25, v29, v29 row_ror:8 row_mask:0xf bank_mask:0xc
    v_add_f32_dpp v41, v45, v45 row_ror:8 row_mask:0xf bank_mask:0xc
    v_add_f32_dpp v26, v30, v30 row_ror:8 row_mask:0xf bank_mask:0xc
    v_add_f32_dpp v42, v46, v46 row_ror:8 row_mask:0xf bank_mask:0xc
    v_add_f32_dpp v27, v31, v31 row_ror:8 row_mask:0xf bank_mask:0xc
    v_add_f32_dpp v43, v47, v47 row_ror:8 row_mask:0xf bank_mask:0xc
    v_add_f32_dpp v24, v24, v24 row_shl:4 row_mask:0xf bank_mask:0x5
    v_add_f32_dpp v40, v40, v40 row_shl:4 row_mask:0xf bank_mask:0x5
    v_add_f32_dpp v25, v25, v25 row_shl:4 row_mask:0xf bank_mask:0x5
    v_add_f32_dpp v41, v41, v41 row_shl:4 row_mask:0xf bank_mask:0x5
    v_add_f32_dpp v24, v26, v26 row_shr:4 row_mask:0xf bank_mask:0xa
    v_add_f32_dpp v40, v42, v42 row_shr:4 row_mask:0xf bank_mask:0xa
    v_add_f32_dpp v25, v27, v27 row_shr:4 row_mask:0xf bank_mask:0xa
    v_add_f32_dpp v41, v43, v43 row_shr:4 row_mask:0xf bank_mask:0xa
    v_add_f32_dpp v24, v24, v24 quad_perm:[1,0,3,2] row_mask:0xf bank_mask:0xf
    v_add_f32_dpp v40, v40, v40 quad_perm:[1,0,3,2] row_mask:0xf bank_mask:0xf
    v_add_f32_dpp v25, v25, v25 quad_perm:[1,0,3,2] row_mask:0xf bank_mask:0xf
    v_add_f32_dpp v41, v41, v41 quad_perm:[1,0,3,2] row_mask:0xf bank_mask:0xf
    v_add_f32_dpp v24, v24, v24 quad_perm:[2,3,0,1] row_mask:0xf bank_mask:0xf
    v_add_f32_dpp v40, v40, v40 quad_perm:[2,3,0,1] row_mask:0xf bank_mask:0xf
    v_add_f32_dpp v25, v25, v25 quad_perm:[2,3,0,1] row_mask:0xf bank_mask:0xf
    v_add_f32_dpp v41, v41, v41 quad_perm:[2,3,0,1] row_mask:0xf bank_mask:0xf
    v_cndmask_b32 v28, v24, v25, vcc
    v_cndmask_b32 v29, v40, v41, vcc
    v_mov_b32 v30, v3
    s_mov_b32 exec_lo, 0x33333333
    s_mov_b32 exec_hi, 0x33333333
    buffer_store_dwordx4 v[28:31], v18, s[48:51], s71 offen sc1
    s_mov_b64 exec, -1
    s_waitcnt vmcnt(9)
    s_waitcnt lgkmcnt(0)
    s_barrier
    ds_read_b128 a[192:195], v11 offset:0
    ds_read_b128 a[196:199], v11 offset:1024
    ds_read_b128 a[200:203], v11 offset:2048
    ds_read_b128 a[204:207], v11 offset:3072
    ds_read_b128 a[208:211], v11 offset:4096
    s_waitcnt lgkmcnt(3)
    v_mfma_f32_32x32x16_bf16 v[208:223], a[192:195], v[64:67], 0
    ds_read_b128 a[212:215], v11 offset:5120
    s_add_u32 m0, s73, 8448
    s_add_u32 s76, s77, 32768
    s_add_u32 s65, s83, 65536
    s_add_u32 s66, s83, 131072
    v_mfma_f32_32x32x16_bf16 v[208:223], a[196:199], v[68:71], v[208:223]
    buffer_load_dwordx4 v240, s[24:27], s76 offen lds
    ds_read_b128 a[216:219], v11 offset:6144
    s_add_u32 s67, s83, 196608
    s_add_u32 s68, s83, 262144
    s_waitcnt lgkmcnt(3)
    v_mfma_f32_32x32x16_bf16 v[208:223], a[200:203], v[72:75], v[208:223]
    buffer_load_dwordx4 v241, s[24:27], s76 offen offset:1056 lds
    ds_read_b128 a[220:223], v11 offset:7168
    s_add_u32 s69, s83, 327680
    s_add_u32 s70, s83, 393216
    v_mfma_f32_32x32x16_bf16 v[208:223], a[204:207], v[76:79], v[208:223]
    buffer_load_dwordx4 v242, s[24:27], s76 offen offset:2112 lds
    ds_read_b128 a[192:195], v11 offset:8192
    s_mul_i32 s40, s55, 148
    s_add_u32 s41, s40, 111
    s_waitcnt lgkmcnt(3)
    v_mfma_f32_32x32x16_bf16 v[208:223], a[208:211], v[80:83], v[208:223]
    ds_read_b128 a[196:199], v11 offset:9216
    s_lshr_b32 s40, s40, 8
    s_lshr_b32 s41, s41, 8
    v_add_u32 v247, s40, v0
    v_mfma_f32_32x32x16_bf16 v[208:223], a[212:215], v[84:87], v[208:223]
    buffer_load_dwordx4 v243, s[24:27], s76 offen offset:3168 lds
    ds_read_b128 a[200:203], v11 offset:10240
    v_lshlrev_b32 v247, 11, v247
    s_sub_u32 s40, s41, s40
    s_lshl1_add_u32 s40, s40, 1
    s_mov_b32 s41, 0
    s_waitcnt lgkmcnt(3)
    v_mfma_f32_32x32x16_bf16 v[208:223], a[216:219], v[88:91], v[208:223]
    ds_read_b128 a[204:207], v11 offset:11264
    s_add_u32 m0, s73, 12672
    s_add_u32 s76, s77, 49152
    s_add_u32 s43, s80, 8192
    s_mul_i32 s88, s52, 50176
    s_lshl_b32 s89, s63, 7
    v_mfma_f32_32x32x16_bf16 v[208:223], a[220:223], v[92:95], v[208:223]
    buffer_load_dwordx4 v240, s[24:27], s76 offen lds
    ds_read_b128 a[208:211], v11 offset:12288
    s_add_u32 s88, s88, s89
    s_mul_i32 s89, s52, 7168
    s_waitcnt lgkmcnt(3)
    v_mfma_f32_32x32x16_bf16 v[208:223], a[192:195], v[96:99], v[208:223]
    buffer_load_dwordx4 v241, s[24:27], s76 offen offset:1056 lds
    ds_read_b128 a[212:215], v11 offset:13312
    v_mfma_f32_32x32x16_bf16 v[208:223], a[196:199], v[100:103], v[208:223]
    ds_read_b128 a[216:219], v11 offset:14336
    s_waitcnt lgkmcnt(3)
    v_mfma_f32_32x32x16_bf16 v[208:223], a[200:203], v[104:107], v[208:223]
    buffer_load_dwordx4 v242, s[24:27], s76 offen offset:2112 lds
    ds_read_b128 a[220:223], v11 offset:15360
    v_mfma_f32_32x32x16_bf16 v[208:223], a[204:207], v[108:111], v[208:223]
    buffer_load_dwordx4 v243, s[24:27], s76 offen offset:3168 lds
    ds_read_b128 a[192:195], v11 offset:16384
    s_waitcnt lgkmcnt(3)
    v_mfma_f32_32x32x16_bf16 v[208:223], a[208:211], v[112:115], v[208:223]
    ds_read_b128 a[196:199], v11 offset:17408
    v_mfma_f32_32x32x16_bf16 v[208:223], a[212:215], v[116:119], v[208:223]
    ds_read_b128 a[200:203], v11 offset:18432
    s_waitcnt lgkmcnt(3)
    v_mfma_f32_32x32x16_bf16 v[208:223], a[216:219], v[120:123], v[208:223]
    ds_read_b128 a[204:207], v11 offset:19456
    v_mfma_f32_32x32x16_bf16 v[208:223], a[220:223], v[124:127], v[208:223]
    ds_read_b128 a[208:211], v11 offset:20480
    s_waitcnt lgkmcnt(3)
    v_mfma_f32_32x32x16_bf16 v[208:223], a[192:195], v[128:131], v[208:223]
    ds_read_b128 a[212:215], v11 offset:21504
    v_mfma_f32_32x32x16_bf16 v[208:223], a[196:199], v[132:135], v[208:223]
    ds_read_b128 a[216:219], v11 offset:22528
    s_waitcnt lgkmcnt(3)
    v_mfma_f32_32x32x16_bf16 v[208:223], a[200:203], v[136:139], v[208:223]
    buffer_load_dwordx4 v[24:27], v19, s[48:51], s83 offen sc1
    ds_read_b128 a[220:223], v11 offset:23552
    buffer_load_dwordx4 v[28:31], v19, s[48:51], s65 offen sc1
    v_mfma_f32_32x32x16_bf16 v[208:223], a[204:207], v[140:143], v[208:223]
    buffer_load_dwordx4 v[32:35], v19, s[48:51], s66 offen sc1
    ds_read_b128 a[192:195], v11 offset:24576
    buffer_load_dwordx4 v[36:39], v19, s[48:51], s67 offen sc1
    s_waitcnt lgkmcnt(3)
    v_mfma_f32_32x32x16_bf16 v[208:223], a[208:211], v[144:147], v[208:223]
    buffer_load_dwordx4 v[40:43], v19, s[48:51], s68 offen sc1
    ds_read_b128 a[196:199], v11 offset:25600
    buffer_load_dwordx4 v[44:47], v19, s[48:51], s69 offen sc1
    v_mfma_f32_32x32x16_bf16 v[208:223], a[212:215], v[148:151], v[208:223]
    buffer_load_dwordx4 v[48:51], v19, s[48:51], s70 offen sc1
    ds_read_b128 a[200:203], v11 offset:26624
    s_waitcnt lgkmcnt(3)
    v_mfma_f32_32x32x16_bf16 v[208:223], a[216:219], v[152:155], v[208:223]
    ds_read_b128 a[204:207], v11 offset:27648
    v_mfma_f32_32x32x16_bf16 v[208:223], a[220:223], v[156:159], v[208:223]
    ds_read_b128 a[208:211], v11 offset:28672
    s_waitcnt lgkmcnt(3)
    v_mfma_f32_32x32x16_bf16 v[208:223], a[192:195], v[160:163], v[208:223]
    ds_read_b128 a[212:215], v11 offset:29696
    v_mfma_f32_32x32x16_bf16 v[208:223], a[196:199], v[164:167], v[208:223]
    ds_read_b128 a[216:219], v11 offset:30720
    s_waitcnt lgkmcnt(3)
    v_mfma_f32_32x32x16_bf16 v[208:223], a[200:203], v[168:171], v[208:223]
    buffer_load_ushort v14, v15, s[28:31], s17 offen
    ds_read_b128 a[220:223], v11 offset:31744
    v_mfma_f32_32x32x16_bf16 v[208:223], a[204:207], v[172:175], v[208:223]
    ds_read_b128 a[192:195], v11 offset:32768
    s_waitcnt lgkmcnt(3)
    v_mfma_f32_32x32x16_bf16 v[208:223], a[208:211], v[20:23], v[208:223]
    ds_read_b128 a[196:199], v11 offset:33792
    v_mfma_f32_32x32x16_bf16 v[208:223], a[212:215], v[20:23], v[208:223]
    ds_read_b128 a[200:203], v11 offset:34816
    s_waitcnt lgkmcnt(3)
    v_mfma_f32_32x32x16_bf16 v[224:239], a[216:219], v[64:67], 0
    ds_read_b128 a[204:207], v11 offset:35840
    v_lshrrev_b32 v240, 3, v0
    v_and_b32 v241, 6, v240
    v_mul_u32_u24 v240, 896, v240
    v_mfma_f32_32x32x16_bf16 v[224:239], a[220:223], v[68:71], v[224:239]
    ds_read_b128 a[208:211], v11 offset:36864
    v_xor_b32 v241, v241, v0
    v_and_b32_e64 v241, 7, v241
    v_lshl_add_u32 v240, v241, 4, v240
    s_waitcnt lgkmcnt(3)
    v_mfma_f32_32x32x16_bf16 v[224:239], a[192:195], v[72:75], v[224:239]
    ds_read_b128 a[212:215], v11 offset:37888
    v_add_u32 v241, 6144, v240
    v_add_u32 v242, 12288, v240
    v_add_u32 v243, 18432, v240
    v_mfma_f32_32x32x16_bf16 v[224:239], a[196:199], v[76:79], v[224:239]
    ds_read_b128 a[216:219], v11 offset:38912
    v_mul_f32 v60, v208, v208
    v_mul_f32 v61, v209, v209
    v_fma_f32 v60, v60, v16, v17
    s_waitcnt lgkmcnt(3)
    v_mfma_f32_32x32x16_bf16 v[224:239], a[200:203], v[80:83], v[224:239]
    ds_read_b128 a[220:223], v11 offset:39936
    v_fma_f32 v61, v61, v16, v17
    v_mul_f32 v60, v60, v208
    v_mul_f32 v61, v61, v209
    v_mfma_f32_32x32x16_bf16 v[224:239], a[204:207], v[84:87], v[224:239]
    s_branch L_page5
.p2align 12
L_stub5:
    s_branch L_walked
L_page5:
    ds_read_b128 a[192:195], v11 offset:40960
    v_exp_f32 v60, v60
    v_exp_f32 v61, v61
    v_fma_f32 v60, v60, v9, v9
    s_waitcnt lgkmcnt(3)
    v_mfma_f32_32x32x16_bf16 v[224:239], a[208:211], v[88:91], v[224:239]
    ds_read_b128 a[196:199], v11 offset:41984
    v_fma_f32 v61, v61, v9, v9
    v_rcp_f32 v60, v60
    v_rcp_f32 v61, v61
    v_mfma_f32_32x32x16_bf16 v[224:239], a[212:215], v[92:95], v[224:239]
    ds_read_b128 a[200:203], v11 offset:43008
    v_mul_f32 v208, v208, v60
    v_mul_f32 v209, v209, v61
    s_waitcnt lgkmcnt(3)
    v_mfma_f32_32x32x16_bf16 v[224:239], a[216:219], v[96:99], v[224:239]
    ds_read_b128 a[204:207], v11 offset:44032
    s_waitcnt vmcnt(1)
    v_xor_b32_e64 v26, s53, v26
    v_bitop3_b32 v26, v26, v30, s53 bitop3:0xf6
    v_bitop3_b32 v26, v26, v34, s53 bitop3:0xf6
    v_bitop3_b32 v26, v26, v38, s53 bitop3:0xf6
    v_bitop3_b32 v26, v26, v42, s53 bitop3:0xf6
    v_mfma_f32_32x32x16_bf16 v[224:239], a[220:223], v[100:103], v[224:239]
    ds_read_b128 a[208:211], v11 offset:45056
    v_bitop3_b32 v26, v26, v46, s53 bitop3:0xf6
    v_bitop3_b32 v26, v26, v50, s53 bitop3:0xf6
    v_cmp_ne_u32 vcc, 0, v26
    s_nop 0
    s_cbranch_vccnz L_s5retry
L_s5ok:
    v_add_f32 v24, v24, v28
    s_waitcnt lgkmcnt(3)
    v_mfma_f32_32x32x16_bf16 v[224:239], a[192:195], v[104:107], v[224:239]
    ds_read_b128 a[212:215], v11 offset:46080
    v_add_f32 v25, v25, v29
    v_add_f32 v24, v24, v32
    v_add_f32 v25, v25, v33
    v_add_f32 v24, v24, v36
    v_add_f32 v25, v25, v37
    v_mfma_f32_32x32x16_bf16 v[224:239], a[196:199], v[108:111], v[224:239]
    ds_read_b128 a[216:219], v11 offset:47104
    v_add_f32 v24, v24, v40
    v_add_f32 v25, v25, v41
    v_add_f32 v24, v24, v44
    v_add_f32 v25, v25, v45
    v_add_f32 v24, v24, v48
    s_waitcnt lgkmcnt(3)
    v_mfma_f32_32x32x16_bf16 v[224:239], a[200:203], v[112:115], v[224:239]
    ds_read_b128 a[220:223], v11 offset:48128
    v_add_f32 v25, v25, v49
    s_nop 1
    v_permlane32_swap_b32 v24, v25
    v_add_f32 v24, v24, v25
    v_mul_f32 v24, 0x3a924925, v24
    v_mov_b32 v25, v24
    s_nop 1
    v_permlane32_swap_b32 v24, v25
    v_mfma_f32_32x32x16_bf16 v[224:239], a[204:207], v[116:119], v[224:239]
    ds_read_b128 a[192:195], v11 offset:49152
    v_fma_f32 v25, -v24, v24, v25
    v_max_f32 v25, 0, v25
    v_add_f32 v25, v25, v10
    v_rsq_f32 v25, v25
    s_nop 0
    v_mul_f32 v24, v24, -v25
    s_waitcnt lgkmcnt(3)
    v_mfma_f32_32x32x16_bf16 v[224:239], a[208:211], v[120:123], v[224:239]
    ds_read_b128 a[196:199], v11 offset:50176
    ds_write_b32 v6, v25
    ds_write_b32 v6, v24 offset:128
    ds_read_b128 v[24:27], v7 offset:0
    ds_read_b128 v[40:43], v7 offset:128
    ds_read_b128 v[28:31], v7 offset:32
    v_mfma_f32_32x32x16_bf16 v[224:239], a[212:215], v[124:127], v[224:239]
    ds_read_b128 a[200:203], v11 offset:51200
    ds_read_b128 v[44:47], v7 offset:160
    ds_read_b128 v[32:35], v7 offset:64
    ds_read_b128 v[48:51], v7 offset:192
    ds_read_b128 v[36:39], v7 offset:96
    ds_read_b128 v[52:55], v7 offset:224
    s_waitcnt lgkmcnt(4)
    v_pk_fma_f32 v[176:177], v[176:177], v[24:25], v[40:41]
    v_cvt_pk_bf16_f32 v176, v176, v177
    v_pk_fma_f32 v[178:179], v[178:179], v[26:27], v[42:43]
    v_cvt_pk_bf16_f32 v177, v178, v179
    v_pk_fma_f32 v[180:181], v[180:181], v[28:29], v[44:45]
    v_cvt_pk_bf16_f32 v178, v180, v181
    v_pk_fma_f32 v[182:183], v[182:183], v[30:31], v[46:47]
    v_cvt_pk_bf16_f32 v179, v182, v183
    buffer_store_dwordx4 v[176:179], v244, s[48:51], s85 offen offset:0 sc1
    v_pk_fma_f32 v[192:193], v[192:193], v[24:25], v[40:41]
    v_cvt_pk_bf16_f32 v192, v192, v193
    v_pk_fma_f32 v[194:195], v[194:195], v[26:27], v[42:43]
    v_cvt_pk_bf16_f32 v193, v194, v195
    v_pk_fma_f32 v[196:197], v[196:197], v[28:29], v[44:45]
    v_cvt_pk_bf16_f32 v194, v196, v197
    v_pk_fma_f32 v[198:199], v[198:199], v[30:31], v[46:47]
    v_cvt_pk_bf16_f32 v195, v198, v199
    buffer_store_dwordx4 v[192:195], v244, s[48:51], s87 offen offset:0 sc1
    s_waitcnt lgkmcnt(0)
    v_pk_fma_f32 v[184:185], v[184:185], v[32:33], v[48:49]
    v_cvt_pk_bf16_f32 v184, v184, v185
    v_pk_fma_f32 v[186:187], v[186:187], v[34:35], v[50:51]
    v_cvt_pk_bf16_f32 v185, v186, v187
    v_pk_fma_f32 v[188:189], v[188:189], v[36:37], v[52:53]
    v_cvt_pk_bf16_f32 v186, v188, v189
    v_pk_fma_f32 v[190:191], v[190:191], v[38:39], v[54:55]
    v_cvt_pk_bf16_f32 v187, v190, v191
    buffer_store_dwordx4 v[184:187], v244, s[48:51], s85 offen offset:512 sc1
    v_pk_fma_f32 v[200:201], v[200:201], v[32:33], v[48:49]
    v_cvt_pk_bf16_f32 v200, v200, v201
    v_pk_fma_f32 v[202:203], v[202:203], v[34:35], v[50:51]
    v_cvt_pk_bf16_f32 v201, v202, v203
    v_pk_fma_f32 v[204:205], v[204:205], v[36:37], v[52:53]
    v_cvt_pk_bf16_f32 v202, v204, v205
    v_pk_fma_f32 v[206:207], v[206:207], v[38:39], v[54:55]
    v_cvt_pk_bf16_f32 v203, v206, v207
    buffer_store_dwordx4 v[200:203], v244, s[48:51], s87 offen offset:512 sc1
    v_mfma_f32_32x32x16_bf16 v[224:239], a[216:219], v[128:131], v[224:239]
    ds_read_b128 a[204:207], v11 offset:52224
    v_mul_f32 v62, v210, v210
    v_mul_f32 v63, v211, v211
    v_fma_f32 v62, v62, v16, v17
    v_fma_f32 v63, v63, v16, v17
    v_mul_f32 v62, v62, v210
    v_mul_f32 v63, v63, v211
    v_exp_f32 v62, v62
    v_exp_f32 v63, v63
    v_mfma_f32_32x32x16_bf16 v[224:239], a[220:223], v[132:135], v[224:239]
    ds_read_b128 a[208:211], v11 offset:53248
    v_fma_f32 v62, v62, v9, v9
    v_fma_f32 v63, v63, v9, v9
    v_rcp_f32 v62, v62
    v_rcp_f32 v63, v63
    v_mul_f32 v210, v210, v62
    v_mul_f32 v211, v211, v63
    v_mul_f32 v60, v212, v212
    v_mul_f32 v61, v213, v213
    v_mfma_f32_32x32x16_bf16 v[224:239], a[192:195], v[136:139], v[224:239]
    ds_read_b128 a[212:215], v11 offset:54272
    v_fma_f32 v60, v60, v16, v17
    v_fma_f32 v61, v61, v16, v17
    v_mul_f32 v60, v60, v212
    v_mul_f32 v61, v61, v213
    v_exp_f32 v60, v60
    v_exp_f32 v61, v61
    v_fma_f32 v60, v60, v9, v9
    v_fma_f32 v61, v61, v9, v9
    v_mfma_f32_32x32x16_bf16 v[224:239], a[196:199], v[140:143], v[224:239]
    ds_read_b128 a[216:219], v11 offset:55296
    v_rcp_f32 v60, v60
    v_rcp_f32 v61, v61
    v_mul_f32 v212, v212, v60
    v_mul_f32 v213, v213, v61
    v_mul_f32 v62, v214, v214
    v_mul_f32 v63, v215, v215
    v_fma_f32 v62, v62, v16, v17
    s_waitcnt lgkmcnt(3)
    v_mfma_f32_32x32x16_bf16 v[224:239], a[200:203], v[144:147], v[224:239]
    ds_read_b128 a[220:223], v11 offset:56320
    s_barrier
    v_fma_f32 v63, v63, v16, v17
    v_mul_f32 v62, v62, v214
    v_mul_f32 v63, v63, v215
    v_exp_f32 v62, v62
    v_exp_f32 v63, v63
    v_fma_f32 v62, v62, v9, v9
    s_add_u32 m0, s89, 92160
    s_add_u32 s76, s88, 0
    v_mfma_f32_32x32x16_bf16 v[224:239], a[204:207], v[148:151], v[224:239]
    buffer_load_dwordx4 v240, s[32:35], s76 offen lds
    ds_read_b128 a[192:195], v11 offset:57344
    v_fma_f32 v63, v63, v9, v9
    v_rcp_f32 v62, v62
    v_rcp_f32 v63, v63
    v_mul_f32 v214, v214, v62
    v_mul_f32 v215, v215, v63
    v_mul_f32 v60, v216, v216
    v_mul_f32 v61, v217, v217
    s_waitcnt lgkmcnt(3)
    v_mfma_f32_32x32x16_bf16 v[224:239], a[208:211], v[152:155], v[224:239]
    ds_read_b128 a[196:199], v11 offset:58368
    v_fma_f32 v60, v60, v16, v17
    v_fma_f32 v61, v61, v16, v17
    v_mul_f32 v60, v60, v216
    v_mul_f32 v61, v61, v217
    v_exp_f32 v60, v60
    v_exp_f32 v61, v61
    v_fma_f32 v60, v60, v9, v9
    v_mfma_f32_32x32x16_bf16 v[224:239], a[212:215], v[156:159], v[224:239]
    buffer_load_dwordx4 v241, s[32:35], s76 offen offset:1024 lds
    ds_read_b128 a[200:203], v11 offset:59392
    v_fma_f32 v61, v61, v9, v9
    v_rcp_f32 v60, v60
    v_rcp_f32 v61, v61
    v_mul_f32 v216, v216, v60
    v_mul_f32 v217, v217, v61
    v_mul_f32 v62, v218, v218
    v_mul_f32 v63, v219, v219
    s_waitcnt lgkmcnt(3)
    v_mfma_f32_32x32x16_bf16 v[224:239], a[216:219], v[160:163], v[224:239]
    buffer_load_dwordx4 v242, s[32:35], s76 offen offset:2048 lds
    ds_read_b128 a[204:207], v11 offset:60416
    v_fma_f32 v62, v62, v16, v17
    v_fma_f32 v63, v63, v16, v17
    v_mul_f32 v62, v62, v218
    v_mul_f32 v63, v63, v219
    v_exp_f32 v62, v62
    v_exp_f32 v63, v63
    v_fma_f32 v62, v62, v9, v9
    v_mfma_f32_32x32x16_bf16 v[224:239], a[220:223], v[164:167], v[224:239]
    buffer_load_dwordx4 v243, s[32:35], s76 offen offset:3072 lds
    v_fma_f32 v63, v63, v9, v9
    v_rcp_f32 v62, v62
    v_rcp_f32 v63, v63
    v_mul_f32 v218, v218, v62
    v_mul_f32 v219, v219, v63
    v_mul_f32 v60, v220, v220
    s_add_u32 m0, s89, 96256
    s_add_u32 s76, s88, 28672
    s_waitcnt lgkmcnt(2)
    v_mfma_f32_32x32x16_bf16 v[224:239], a[192:195], v[168:171], v[224:239]
    v_mul_f32 v61, v221, v221
    v_fma_f32 v60, v60, v16, v17
    v_fma_f32 v61, v61, v16, v17
    v_mul_f32 v60, v60, v220
    v_mul_f32 v61, v61, v221
    v_exp_f32 v60, v60
    v_exp_f32 v61, v61
    v_mfma_f32_32x32x16_bf16 v[224:239], a[196:199], v[172:175], v[224:239]
    buffer_load_dwordx4 v240, s[32:35], s76 offen lds
    v_fma_f32 v60, v60, v9, v9
    v_fma_f32 v61, v61, v9, v9
    v_rcp_f32 v60, v60
    v_rcp_f32 v61, v61
    v_mul_f32 v220, v220, v60
    v_mul_f32 v221, v221, v61
    v_mul_f32 v62, v222, v222
    s_waitcnt lgkmcnt(0)
    v_mfma_f32_32x32x16_bf16 v[224:239], a[200:203], v[20:23], v[224:239]
    buffer_load_dwordx4 v241, s[32:35], s76 offen offset:1024 lds
    v_mul_f32 v63, v223, v223
    v_fma_f32 v62, v62, v16, v17
    v_fma_f32 v63, v63, v16, v17
    v_mul_f32 v62, v62, v222
    v_mul_f32 v63, v63, v223
    v_exp_f32 v62, v62
    v_exp_f32 v63, v63
    v_mfma_f32_32x32x16_bf16 v[224:239], a[204:207], v[20:23], v[224:239]
    buffer_load_dwordx4 v242, s[32:35], s76 offen offset:2048 lds
    v_fma_f32 v62, v62, v9, v9
    v_fma_f32 v63, v63, v9, v9
    v_rcp_f32 v62, v62
    v_rcp_f32 v63, v63
    v_mul_f32 v222, v222, v62
    v_mul_f32 v223, v223, v63
    s_waitcnt vmcnt(7)
    s_barrier
    s_mov_b64 exec, s[40:41]
    buffer_atomic_add v3, v247, s[48:51], s75 offen sc1
    s_mov_b64 exec, -1
    v_cvt_pk_bf16_f32 v128, v208, v209
    s_add_u32 m0, s89, 120832
    s_add_u32 s76, s88, 200704
    v_cvt_pk_bf16_f32 v129, v210, v211
    v_cvt_pk_bf16_f32 v130, v216, v217
    v_cvt_pk_bf16_f32 v131, v218, v219
    buffer_store_dwordx4 v[128:131], v245, s[48:51], s84 offen offset:0 sc1
    v_cvt_pk_bf16_f32 v132, v212, v213
    v_cvt_pk_bf16_f32 v133, v214, v215
    v_cvt_pk_bf16_f32 v134, v220, v221
    v_cvt_pk_bf16_f32 v135, v222, v223
    buffer_load_dwordx4 v240, s[32:35], s76 offen lds
    buffer_store_dwordx4 v[132:135], v245, s[48:51], s84 offen offset:512 sc1
    v_and_b32 v56, 15, v0
    v_mul_u32_u24 v56, 1056, v56
    v_and_b32_e64 v57, 48, v0
    v_add3_u32 v56, v56, v57, s73
    ds_read_b128 a[192:195], v56 offset:0
    ds_read_b128 a[196:199], v56 offset:64
    buffer_load_dwordx4 v241, s[32:35], s76 offen offset:1024 lds
    ds_read_b128 a[200:203], v56 offset:128
    ds_read_b128 a[204:207], v56 offset:192
    ds_read_b128 a[208:211], v56 offset:256
    ds_read_b128 a[212:215], v56 offset:320
    ds_read_b128 a[216:219], v56 offset:384
    ds_read_b128 a[220:223], v56 offset:448
    ds_read_b128 a[224:227], v56 offset:512
    ds_read_b128 a[228:231], v56 offset:576
    buffer_load_dwordx4 v242, s[32:35], s76 offen offset:2048 lds
    ds_read_b128 a[232:235], v56 offset:640
    ds_read_b128 a[236:239], v56 offset:704
    ds_read_b128 a[240:243], v56 offset:768
    ds_read_b128 a[244:247], v56 offset:832
    ds_read_b128 a[248:251], v56 offset:896
    ds_read_b128 a[252:255], v56 offset:960
    v_add_u32 v124, 4096, v1
    v_add_u32 v125, 8192, v1
    buffer_load_dwordx4 v243, s[32:35], s76 offen offset:3072 lds
    v_add_u32 v126, 12288, v1
    v_add_u32 v123, s36, v1
    v_add_u32 v120, s37, v1
    v_add_u32 v121, s38, v1
    v_add_u32 v122, s39, v1
    v_pk_mul_f32 v[60:61], v[224:225], v[224:225]
    v_pk_mul_f32 v[62:63], v[226:227], v[226:227]
    v_pk_fma_f32 v[60:61], v[60:61], v[16:17], v[16:17] op_sel:[0,0,1] op_sel_hi:[1,0,1]
    v_pk_fma_f32 v[62:63], v[62:63], v[16:17], v[16:17] op_sel:[0,0,1] op_sel_hi:[1,0,1]
    s_add_u32 m0, s89, 124928
    s_add_u32 s76, s88, 229376
    v_pk_mul_f32 v[60:61], v[60:61], v[224:225]
    v_pk_mul_f32 v[62:63], v[62:63], v[226:227]
    v_exp_f32 v60, v60
    v_exp_f32 v61, v61
    v_exp_f32 v62, v62
    v_exp_f32 v63, v63
    v_pk_fma_f32 v[60:61], v[60:61], v[8:9], v[8:9] op_sel:[0,1,1] op_sel_hi:[1,1,1]
    v_pk_fma_f32 v[62:63], v[62:63], v[8:9], v[8:9] op_sel:[0,1,1] op_sel_hi:[1,1,1]
    buffer_load_dwordx4 v240, s[32:35], s76 offen lds
    v_rcp_f32 v60, v60
    v_rcp_f32 v61, v61
    v_rcp_f32 v62, v62
    v_rcp_f32 v63, v63
    v_pk_mul_f32 v[224:225], v[224:225], v[60:61]
    v_pk_mul_f32 v[226:227], v[226:227], v[62:63]
    v_pk_mul_f32 v[60:61], v[228:229], v[228:229]
    v_pk_mul_f32 v[62:63], v[230:231], v[230:231]
    buffer_load_dwordx4 v241, s[32:35], s76 offen offset:1024 lds
    v_pk_fma_f32 v[60:61], v[60:61], v[16:17], v[16:17] op_sel:[0,0,1] op_sel_hi:[1,0,1]
    v_pk_fma_f32 v[62:63], v[62:63], v[16:17], v[16:17] op_sel:[0,0,1] op_sel_hi:[1,0,1]
    v_pk_mul_f32 v[60:61], v[60:61], v[228:229]
    v_pk_mul_f32 v[62:63], v[62:63], v[230:231]
    v_exp_f32 v60, v60
    v_exp_f32 v61, v61
    v_exp_f32 v62, v62
    v_exp_f32 v63, v63
    buffer_load_dwordx4 v242, s[32:35], s76 offen offset:2048 lds
    v_pk_fma_f32 v[60:61], v[60:61], v[8:9], v[8:9] op_sel:[0,1,1] op_sel_hi:[1,1,1]
    v_pk_fma_f32 v[62:63], v[62:63], v[8:9], v[8:9] op_sel:[0,1,1] op_sel_hi:[1,1,1]
    v_rcp_f32 v60, v60
    v_rcp_f32 v61, v61
    v_rcp_f32 v62, v62
    v_rcp_f32 v63, v63
    v_pk_mul_f32 v[228:229], v[228:229], v[60:61]
    v_pk_mul_f32 v[230:231], v[230:231], v[62:63]
    s_mov_b64 exec, 1
    v_mov_b32_e64 v6, 0
    buffer_atomic_add v6, off, s[48:51], s10 sc0 sc1
    s_mov_b64 exec, -1
    v_pk_mul_f32 v[60:61], v[232:233], v[232:233]
    v_pk_mul_f32 v[62:63], v[234:235], v[234:235]
    v_pk_fma_f32 v[60:61], v[60:61], v[16:17], v[16:17] op_sel:[0,0,1] op_sel_hi:[1,0,1]
    v_pk_fma_f32 v[62:63], v[62:63], v[16:17], v[16:17] op_sel:[0,0,1] op_sel_hi:[1,0,1]
    v_pk_mul_f32 v[60:61], v[60:61], v[232:233]
    v_pk_mul_f32 v[62:63], v[62:63], v[234:235]
    v_exp_f32 v60, v60
    v_exp_f32 v61, v61
    v_exp_f32 v62, v62
    v_exp_f32 v63, v63
    v_pk_fma_f32 v[60:61], v[60:61], v[8:9], v[8:9] op_sel:[0,1,1] op_sel_hi:[1,1,1]
    v_pk_fma_f32 v[62:63], v[62:63], v[8:9], v[8:9] op_sel:[0,1,1] op_sel_hi:[1,1,1]
    v_rcp_f32 v60, v60
    v_rcp_f32 v61, v61
    v_rcp_f32 v62, v62
    v_rcp_f32 v63, v63
    v_pk_mul_f32 v[232:233], v[232:233], v[60:61]
    v_pk_mul_f32 v[234:235], v[234:235], v[62:63]
    v_pk_mul_f32 v[60:61], v[236:237], v[236:237]
    v_pk_mul_f32 v[62:63], v[238:239], v[238:239]
    v_pk_fma_f32 v[60:61], v[60:61], v[16:17], v[16:17] op_sel:[0,0,1] op_sel_hi:[1,0,1]
    v_pk_fma_f32 v[62:63], v[62:63], v[16:17], v[16:17] op_sel:[0,0,1] op_sel_hi:[1,0,1]
    v_pk_mul_f32 v[60:61], v[60:61], v[236:237]
    v_pk_mul_f32 v[62:63], v[62:63], v[238:239]
    v_exp_f32 v60, v60
    v_exp_f32 v61, v61
    v_exp_f32 v62, v62
    v_exp_f32 v63, v63
    v_pk_fma_f32 v[60:61], v[60:61], v[8:9], v[8:9] op_sel:[0,1,1] op_sel_hi:[1,1,1]
    v_pk_fma_f32 v[62:63], v[62:63], v[8:9], v[8:9] op_sel:[0,1,1] op_sel_hi:[1,1,1]
    v_rcp_f32 v60, v60
    v_rcp_f32 v61, v61
    v_rcp_f32 v62, v62
    v_rcp_f32 v63, v63
    v_pk_mul_f32 v[236:237], v[236:237], v[60:61]
    v_pk_mul_f32 v[238:239], v[238:239], v[62:63]
    v_cvt_pk_bf16_f32 v136, v224, v225
    v_cvt_pk_bf16_f32 v137, v226, v227
    v_cvt_pk_bf16_f32 v138, v232, v233
    v_cvt_pk_bf16_f32 v139, v234, v235
    buffer_store_dwordx4 v[136:139], v245, s[48:51], s84 offen offset:1024 sc1
    v_cvt_pk_bf16_f32 v140, v228, v229
    v_cvt_pk_bf16_f32 v141, v230, v231
    v_cvt_pk_bf16_f32 v142, v236, v237
    v_cvt_pk_bf16_f32 v143, v238, v239
    buffer_store_dwordx4 v[140:143], v245, s[48:51], s84 offen offset:1536 sc1
    s_waitcnt vmcnt(2)
    v_readfirstlane_b32 s79, v6
    s_nop 0
    s_cmp_lg_u32 s22, s79
    s_cbranch_scc1 L_s6wait
L_p3:
    buffer_load_dwordx4 v[64:67], v1, s[48:51], s7 offen offset:0 sc1
    buffer_load_dwordx4 v[68:71], v1, s[48:51], s7 offen offset:1024 sc1
    buffer_load_dwordx4 v[72:75], v1, s[48:51], s7 offen offset:2048 sc1
    buffer_load_dwordx4 v[76:79], v1, s[48:51], s7 offen offset:3072 sc1
    buffer_load_dwordx4 v[80:83], v124, s[48:51], s7 offen offset:0 sc1
    buffer_load_dwordx4 v[84:87], v124, s[48:51], s7 offen offset:1024 sc1
    buffer_load_dwordx4 v[88:91], v124, s[48:51], s7 offen offset:2048 sc1
    buffer_load_dwordx4 v[92:95], v124, s[48:51], s7 offen offset:3072 sc1
    s_waitcnt lgkmcnt(0)
    s_waitcnt vmcnt(7)
    v_mfma_f32_16x16x32_bf16 v[16:19], v[64:67], a[0:3], 0
    buffer_load_dwordx4 v[96:99], v125, s[48:51], s7 offen offset:0 sc1
    v_mfma_f32_16x16x32_bf16 v[20:23], v[64:67], a[64:67], 0
    s_mov_b64 exec, 1
    buffer_atomic_add v3, off, s[48:51], s43 sc1
    s_mov_b64 exec, -1
    v_mfma_f32_16x16x32_bf16 v[24:27], v[64:67], a[128:131], 0
    buffer_load_dwordx4 v[100:103], v125, s[48:51], s7 offen offset:1024 sc1
    v_mfma_f32_16x16x32_bf16 v[28:31], v[64:67], a[192:195], 0
    s_waitcnt vmcnt(9)
    v_mfma_f32_16x16x32_bf16 v[16:19], v[68:71], a[4:7], v[16:19]
    buffer_load_dwordx4 v[104:107], v125, s[48:51], s7 offen offset:2048 sc1
    v_mfma_f32_16x16x32_bf16 v[20:23], v[68:71], a[68:71], v[20:23]
    v_lshlrev_b32 v14, 16, v14
    v_mfma_f32_16x16x32_bf16 v[24:27], v[68:71], a[132:135], v[24:27]
    buffer_load_dwordx4 v[108:111], v125, s[48:51], s7 offen offset:3072 sc1
    v_mfma_f32_16x16x32_bf16 v[28:31], v[68:71], a[196:199], v[28:31]
    s_waitcnt vmcnt(10)
    v_mfma_f32_16x16x32_bf16 v[16:19], v[72:75], a[8:11], v[16:19]
    buffer_load_dwordx4 v[112:115], v126, s[48:51], s7 offen offset:0 sc1
    v_mfma_f32_16x16x32_bf16 v[20:23], v[72:75], a[72:75], v[20:23]
    v_mfma_f32_16x16x32_bf16 v[24:27], v[72:75], a[136:139], v[24:27]
    buffer_load_dwordx4 v[116:119], v126, s[48:51], s7 offen offset:1024 sc1
    v_mfma_f32_16x16x32_bf16 v[28:31], v[72:75], a[200:203], v[28:31]
    s_waitcnt vmcnt(11)
    v_mfma_f32_16x16x32_bf16 v[16:19], v[76:79], a[12:15], v[16:19]
    buffer_load_dwordx4 v[64:67], v126, s[48:51], s7 offen offset:2048 sc1
    v_mfma_f32_16x16x32_bf16 v[20:23], v[76:79], a[76:79], v[20:23]
    v_mfma_f32_16x16x32_bf16 v[24:27], v[76:79], a[140:143], v[24:27]
    buffer_load_dwordx4 v[68:71], v126, s[48:51], s7 offen offset:3072 sc1
    v_mfma_f32_16x16x32_bf16 v[28:31], v[76:79], a[204:207], v[28:31]
    s_waitcnt vmcnt(12)
    v_mfma_f32_16x16x32_bf16 v[16:19], v[80:83], a[16:19], v[16:19]
    buffer_load_dwordx4 v[72:75], v1, s[48:51], s6 offen offset:0 sc1
    v_mfma_f32_16x16x32_bf16 v[20:23], v[80:83], a[80:83], v[20:23]
    v_mfma_f32_16x16x32_bf16 v[24:27], v[80:83], a[144:147], v[24:27]
    buffer_load_dwordx4 v[76:79], v1, s[48:51], s6 offen offset:1024 sc1
    v_mfma_f32_16x16x32_bf16 v[28:31], v[80:83], a[208:211], v[28:31]
    s_waitcnt vmcnt(13)
    v_mfma_f32_16x16x32_bf16 v[16:19], v[84:87], a[20:23], v[16:19]
    buffer_load_dwordx4 v[80:83], v1, s[48:51], s6 offen offset:2048 sc1
    v_mfma_f32_16x16x32_bf16 v[20:23], v[84:87], a[84:87], v[20:23]
    v_mfma_f32_16x16x32_bf16 v[24:27], v[84:87], a[148:151], v[24:27]
    v_mfma_f32_16x16x32_bf16 v[28:31], v[84:87], a[212:215], v[28:31]
    s_waitcnt vmcnt(13)
    v_mfma_f32_16x16x32_bf16 v[16:19], v[88:91], a[24:27], v[16:19]
    buffer_load_dwordx4 v[84:87], v1, s[48:51], s6 offen offset:3072 sc1
    v_mfma_f32_16x16x32_bf16 v[20:23], v[88:91], a[88:91], v[20:23]
    v_mfma_f32_16x16x32_bf16 v[24:27], v[88:91], a[152:155], v[24:27]
    v_mfma_f32_16x16x32_bf16 v[28:31], v[88:91], a[216:219], v[28:31]
    s_waitcnt vmcnt(13)
    v_mfma_f32_16x16x32_bf16 v[16:19], v[92:95], a[28:31], v[16:19]
    buffer_load_dwordx4 v[88:91], v124, s[48:51], s6 offen offset:0 sc1
    v_mfma_f32_16x16x32_bf16 v[20:23], v[92:95], a[92:95], v[20:23]
    v_mfma_f32_16x16x32_bf16 v[24:27], v[92:95], a[156:159], v[24:27]
    v_mfma_f32_16x16x32_bf16 v[28:31], v[92:95], a[220:223], v[28:31]
    s_waitcnt vmcnt(13)
    v_mfma_f32_16x16x32_bf16 v[16:19], v[96:99], a[32:35], v[16:19]
    buffer_load_dwordx4 v[92:95], v124, s[48:51], s6 offen offset:1024 sc1
    v_mfma_f32_16x16x32_bf16 v[20:23], v[96:99], a[96:99], v[20:23]
    v_mfma_f32_16x16x32_bf16 v[24:27], v[96:99], a[160:163], v[24:27]
    v_mfma_f32_16x16x32_bf16 v[28:31], v[96:99], a[224:227], v[28:31]
    s_waitcnt vmcnt(12)
    v_mfma_f32_16x16x32_bf16 v[16:19], v[100:103], a[36:39], v[16:19]
    buffer_load_dwordx4 v[96:99], v124, s[48:51], s6 offen offset:2048 sc1
    v_mfma_f32_16x16x32_bf16 v[20:23], v[100:103], a[100:103], v[20:23]
    v_mfma_f32_16x16x32_bf16 v[24:27], v[100:103], a[164:167], v[24:27]
    v_mfma_f32_16x16x32_bf16 v[28:31], v[100:103], a[228:231], v[28:31]
    s_waitcnt vmcnt(12)
    v_mfma_f32_16x16x32_bf16 v[16:19], v[104:107], a[40:43], v[16:19]
    buffer_load_dwordx4 v[100:103], v124, s[48:51], s6 offen offset:3072 sc1
    v_mfma_f32_16x16x32_bf16 v[20:23], v[104:107], a[104:107], v[20:23]
    v_mfma_f32_16x16x32_bf16 v[24:27], v[104:107], a[168:171], v[24:27]
    v_mfma_f32_16x16x32_bf16 v[28:31], v[104:107], a[232:235], v[28:31]
    s_waitcnt vmcnt(12)
    v_mfma_f32_16x16x32_bf16 v[16:19], v[108:111], a[44:47], v[16:19]
    buffer_load_dwordx4 v[104:107], v125, s[48:51], s6 offen offset:0 sc1
    v_mfma_f32_16x16x32_bf16 v[20:23], v[108:111], a[108:111], v[20:23]
    v_mfma_f32_16x16x32_bf16 v[24:27], v[108:111], a[172:175], v[24:27]
    v_mfma_f32_16x16x32_bf16 v[28:31], v[108:111], a[236:239], v[28:31]
    s_waitcnt vmcnt(12)
    v_mfma_f32_16x16x32_bf16 v[16:19], v[112:115], a[48:51], v[16:19]
    buffer_load_dwordx4 v[108:111], v125, s[48:51], s6 offen offset:1024 sc1
    v_mfma_f32_16x16x32_bf16 v[20:23], v[112:115], a[112:115], v[20:23]
    v_mfma_f32_16x16x32_bf16 v[24:27], v[112:115], a[176:179], v[24:27]
    v_mfma_f32_16x16x32_bf16 v[28:31], v[112:115], a[240:243], v[28:31]
    s_waitcnt vmcnt(12)
    v_mfma_f32_16x16x32_bf16 v[16:19], v[116:119], a[52:55], v[16:19]
    buffer_load_dwordx4 v[112:115], v125, s[48:51], s6 offen offset:2048 sc1
    v_mfma_f32_16x16x32_bf16 v[20:23], v[116:119], a[116:119], v[20:23]
    v_mfma_f32_16x16x32_bf16 v[24:27], v[116:119], a[180:183], v[24:27]
    v_mfma_f32_16x16x32_bf16 v[28:31], v[116:119], a[244:247], v[28:31]
    s_waitcnt vmcnt(12)
    v_mfma_f32_16x16x32_bf16 v[16:19], v[64:67], a[56:59], v[16:19]
    buffer_load_dwordx4 v[116:119], v125, s[48:51], s6 offen offset:3072 sc1
    v_mfma_f32_16x16x32_bf16 v[20:23], v[64:67], a[120:123], v[20:23]
    v_mfma_f32_16x16x32_bf16 v[24:27], v[64:67], a[184:187], v[24:27]
    v_mfma_f32_16x16x32_bf16 v[28:31], v[64:67], a[248:251], v[28:31]
    s_waitcnt vmcnt(12)
    v_mfma_f32_16x16x32_bf16 v[16:19], v[68:71], a[60:63], v[16:19]
    buffer_load_dwordx4 v[64:67], v126, s[48:51], s6 offen offset:0 sc1
    v_mfma_f32_16x16x32_bf16 v[20:23], v[68:71], a[124:127], v[20:23]
    v_mfma_f32_16x16x32_bf16 v[24:27], v[68:71], a[188:191], v[24:27]
    v_mfma_f32_16x16x32_bf16 v[28:31], v[68:71], a[252:255], v[28:31]
    s_waitcnt vmcnt(12)
    v_mfma_f32_16x16x32_bf16 v[32:35], v[72:75], a[0:3], 0
    buffer_load_dwordx4 v[68:71], v126, s[48:51], s6 offen offset:1024 sc1
    v_mfma_f32_16x16x32_bf16 v[36:39], v[72:75], a[64:67], 0
    v_mfma_f32_16x16x32_bf16 v[40:43], v[72:75], a[128:131], 0
    v_mfma_f32_16x16x32_bf16 v[44:47], v[72:75], a[192:195], 0
    s_waitcnt vmcnt(12)
    v_mfma_f32_16x16x32_bf16 v[32:35], v[76:79], a[4:7], v[32:35]
    buffer_load_dwordx4 v[72:75], v126, s[48:51], s6 offen offset:2048 sc1
    v_mfma_f32_16x16x32_bf16 v[36:39], v[76:79], a[68:71], v[36:39]
    ds_write_b128 v120, v[20:23] offset:0
    v_mfma_f32_16x16x32_bf16 v[40:43], v[76:79], a[132:135], v[40:43]
    v_mfma_f32_16x16x32_bf16 v[44:47], v[76:79], a[196:199], v[44:47]
    s_waitcnt vmcnt(12)
    v_mfma_f32_16x16x32_bf16 v[32:35], v[80:83], a[8:11], v[32:35]
    buffer_load_dwordx4 v[76:79], v126, s[48:51], s6 offen offset:3072 sc1
    v_mfma_f32_16x16x32_bf16 v[36:39], v[80:83], a[72:75], v[36:39]
    ds_write_b128 v121, v[24:27] offset:0
    v_mfma_f32_16x16x32_bf16 v[40:43], v[80:83], a[136:139], v[40:43]
    v_mfma_f32_16x16x32_bf16 v[44:47], v[80:83], a[200:203], v[44:47]
    s_waitcnt vmcnt(12)
    v_mfma_f32_16x16x32_bf16 v[32:35], v[84:87], a[12:15], v[32:35]
    s_add_u32 s6, s6, 65536
    buffer_load_dwordx4 v[80:83], v1, s[48:51], s6 offen offset:0 sc1
    v_mfma_f32_16x16x32_bf16 v[36:39], v[84:87], a[76:79], v[36:39]
    ds_write_b128 v122, v[28:31] offset:0
    v_mfma_f32_16x16x32_bf16 v[40:43], v[84:87], a[140:143], v[40:43]
    v_mfma_f32_16x16x32_bf16 v[44:47], v[84:87], a[204:207], v[44:47]
    s_waitcnt vmcnt(12)
    v_mfma_f32_16x16x32_bf16 v[32:35], v[88:91], a[16:19], v[32:35]
    buffer_load_dwordx4 v[84:87], v1, s[48:51], s6 offen offset:1024 sc1
    v_mfma_f32_16x16x32_bf16 v[36:39], v[88:91], a[80:83], v[36:39]
    v_add_f32 v16, v16, v14
    v_mfma_f32_16x16x32_bf16 v[40:43], v[88:91], a[144:147], v[40:43]
    v_mfma_f32_16x16x32_bf16 v[44:47], v[88:91], a[208:211], v[44:47]
    s_waitcnt vmcnt(12)
    v_mfma_f32_16x16x32_bf16 v[32:35], v[92:95], a[20:23], v[32:35]
    buffer_load_dwordx4 v[88:91], v1, s[48:51], s6 offen offset:2048 sc1
    v_mfma_f32_16x16x32_bf16 v[36:39], v[92:95], a[84:87], v[36:39]
    v_add_f32 v17, v17, v14
    v_mfma_f32_16x16x32_bf16 v[40:43], v[92:95], a[148:151], v[40:43]
    v_mfma_f32_16x16x32_bf16 v[44:47], v[92:95], a[212:215], v[44:47]
    s_waitcnt lgkmcnt(0)
    s_branch L_page6
.p2align 12
L_stub6:
    s_branch L_walked
L_page6:
    s_barrier
    s_waitcnt vmcnt(12)
    v_mfma_f32_16x16x32_bf16 v[32:35], v[96:99], a[24:27], v[32:35]
    buffer_load_dwordx4 v[92:95], v1, s[48:51], s6 offen offset:3072 sc1
    v_mfma_f32_16x16x32_bf16 v[36:39], v[96:99], a[88:91], v[36:39]
    ds_read_b128 v[48:51], v123 offset:0
    v_mfma_f32_16x16x32_bf16 v[40:43], v[96:99], a[152:155], v[40:43]
    ds_read_b128 v[52:55], v123 offset:1024
    v_mfma_f32_16x16x32_bf16 v[44:47], v[96:99], a[216:219], v[44:47]
    ds_read_b128 v[56:59], v123 offset:2048
    s_waitcnt vmcnt(12)
    v_mfma_f32_16x16x32_bf16 v[32:35], v[100:103], a[28:31], v[32:35]
    buffer_load_dwordx4 v[96:99], v124, s[48:51], s6 offen offset:0 sc1
    v_mfma_f32_16x16x32_bf16 v[36:39], v[100:103], a[92:95], v[36:39]
    v_add_f32 v18, v18, v14
    v_add_f32 v19, v19, v14
    v_mfma_f32_16x16x32_bf16 v[40:43], v[100:103], a[156:159], v[40:43]
    v_mfma_f32_16x16x32_bf16 v[44:47], v[100:103], a[220:223], v[44:47]
    s_waitcnt vmcnt(12)
    v_mfma_f32_16x16x32_bf16 v[32:35], v[104:107], a[32:35], v[32:35]
    buffer_load_dwordx4 v[100:103], v124, s[48:51], s6 offen offset:1024 sc1
    v_mfma_f32_16x16x32_bf16 v[36:39], v[104:107], a[96:99], v[36:39]
    s_waitcnt lgkmcnt(0)
    v_mfma_f32_16x16x32_bf16 v[40:43], v[104:107], a[160:163], v[40:43]
    v_add_f32 v48, v48, v16
    v_mfma_f32_16x16x32_bf16 v[44:47], v[104:107], a[224:227], v[44:47]
    v_add_f32 v49, v49, v17
    s_waitcnt vmcnt(12)
    v_mfma_f32_16x16x32_bf16 v[32:35], v[108:111], a[36:39], v[32:35]
    buffer_load_dwordx4 v[104:107], v124, s[48:51], s6 offen offset:2048 sc1
    v_mfma_f32_16x16x32_bf16 v[36:39], v[108:111], a[100:103], v[36:39]
    v_add_f32 v50, v50, v18
    v_mfma_f32_16x16x32_bf16 v[40:43], v[108:111], a[164:167], v[40:43]
    v_add_f32 v51, v51, v19
    v_mfma_f32_16x16x32_bf16 v[44:47], v[108:111], a[228:231], v[44:47]
    v_add_f32 v52, v52, v56
    s_waitcnt vmcnt(12)
    v_mfma_f32_16x16x32_bf16 v[32:35], v[112:115], a[40:43], v[32:35]
    buffer_load_dwordx4 v[108:111], v124, s[48:51], s6 offen offset:3072 sc1
    v_mfma_f32_16x16x32_bf16 v[36:39], v[112:115], a[104:107], v[36:39]
    v_add_f32 v53, v53, v57
    v_mfma_f32_16x16x32_bf16 v[40:43], v[112:115], a[168:171], v[40:43]
    v_add_f32 v54, v54, v58
    v_mfma_f32_16x16x32_bf16 v[44:47], v[112:115], a[232:235], v[44:47]
    v_add_f32 v55, v55, v59
    s_waitcnt vmcnt(12)
    v_mfma_f32_16x16x32_bf16 v[32:35], v[116:119], a[44:47], v[32:35]
    buffer_load_dwordx4 v[112:115], v125, s[48:51], s6 offen offset:0 sc1
    s_mov_b64 exec, 1
    buffer_load_dword v7, off, s[48:51], s11 sc1
    s_mov_b64 exec, -1
    v_mfma_f32_16x16x32_bf16 v[36:39], v[116:119], a[108:111], v[36:39]
    v_add_f32 v144, v48, v52
    v_mfma_f32_16x16x32_bf16 v[40:43], v[116:119], a[172:175], v[40:43]
    v_add_f32 v145, v49, v53
    v_mfma_f32_16x16x32_bf16 v[44:47], v[116:119], a[236:239], v[44:47]
    v_add_f32 v146, v50, v54
    s_waitcnt vmcnt(13)
    v_mfma_f32_16x16x32_bf16 v[32:35], v[64:67], a[48:51], v[32:35]
    buffer_load_dwordx4 v[116:119], v125, s[48:51], s6 offen offset:1024 sc1
    v_mfma_f32_16x16x32_bf16 v[36:39], v[64:67], a[112:115], v[36:39]
    v_add_f32 v147, v51, v55
    v_mfma_f32_16x16x32_bf16 v[40:43], v[64:67], a[176:179], v[40:43]
    v_mfma_f32_16x16x32_bf16 v[44:47], v[64:67], a[240:243], v[44:47]
    s_waitcnt vmcnt(13)
    v_mfma_f32_16x16x32_bf16 v[32:35], v[68:71], a[52:55], v[32:35]
    buffer_load_dwordx4 v[64:67], v125, s[48:51], s6 offen offset:2048 sc1
    v_mfma_f32_16x16x32_bf16 v[36:39], v[68:71], a[116:119], v[36:39]
    v_mfma_f32_16x16x32_bf16 v[40:43], v[68:71], a[180:183], v[40:43]
    v_mfma_f32_16x16x32_bf16 v[44:47], v[68:71], a[244:247], v[44:47]
    s_waitcnt vmcnt(13)
    v_mfma_f32_16x16x32_bf16 v[32:35], v[72:75], a[56:59], v[32:35]
    buffer_load_dwordx4 v[68:71], v125, s[48:51], s6 offen offset:3072 sc1
    v_mfma_f32_16x16x32_bf16 v[36:39], v[72:75], a[120:123], v[36:39]
    v_mfma_f32_16x16x32_bf16 v[40:43], v[72:75], a[184:187], v[40:43]
    v_mfma_f32_16x16x32_bf16 v[44:47], v[72:75], a[248:251], v[44:47]
    s_waitcnt vmcnt(13)
    v_mfma_f32_16x16x32_bf16 v[32:35], v[76:79], a[60:63], v[32:35]
    buffer_load_dwordx4 v[72:75], v126, s[48:51], s6 offen offset:0 sc1
    v_mfma_f32_16x16x32_bf16 v[36:39], v[76:79], a[124:127], v[36:39]
    v_mfma_f32_16x16x32_bf16 v[40:43], v[76:79], a[188:191], v[40:43]
    v_mfma_f32_16x16x32_bf16 v[44:47], v[76:79], a[252:255], v[44:47]
    s_waitcnt vmcnt(13)
    v_mfma_f32_16x16x32_bf16 v[16:19], v[80:83], a[0:3], 0
    buffer_load_dwordx4 v[76:79], v126, s[48:51], s6 offen offset:1024 sc1
    v_mfma_f32_16x16x32_bf16 v[20:23], v[80:83], a[64:67], 0
    v_mfma_f32_16x16x32_bf16 v[24:27], v[80:83], a[128:131], 0
    v_mfma_f32_16x16x32_bf16 v[28:31], v[80:83], a[192:195], 0
    s_waitcnt vmcnt(13)
    v_mfma_f32_16x16x32_bf16 v[16:19], v[84:87], a[4:7], v[16:19]
    buffer_load_dwordx4 v[80:83], v126, s[48:51], s6 offen offset:2048 sc1
    v_mfma_f32_16x16x32_bf16 v[20:23], v[84:87], a[68:71], v[20:23]
    ds_write_b128 v120, v[36:39] offset:12288
    v_mfma_f32_16x16x32_bf16 v[24:27], v[84:87], a[132:135], v[24:27]
    v_mfma_f32_16x16x32_bf16 v[28:31], v[84:87], a[196:199], v[28:31]
    s_waitcnt vmcnt(13)
    v_mfma_f32_16x16x32_bf16 v[16:19], v[88:91], a[8:11], v[16:19]
    buffer_load_dwordx4 v[84:87], v126, s[48:51], s6 offen offset:3072 sc1
    v_mfma_f32_16x16x32_bf16 v[20:23], v[88:91], a[72:75], v[20:23]
    ds_write_b128 v121, v[40:43] offset:12288
    v_mfma_f32_16x16x32_bf16 v[24:27], v[88:91], a[136:139], v[24:27]
    v_mfma_f32_16x16x32_bf16 v[28:31], v[88:91], a[200:203], v[28:31]
    s_waitcnt vmcnt(13)
    v_mfma_f32_16x16x32_bf16 v[16:19], v[92:95], a[12:15], v[16:19]
    s_add_u32 s6, s6, 65536
    buffer_load_dwordx4 v[88:91], v1, s[48:51], s6 offen offset:0 sc1
    v_mfma_f32_16x16x32_bf16 v[20:23], v[92:95], a[76:79], v[20:23]
    ds_write_b128 v122, v[44:47] offset:12288
    v_mfma_f32_16x16x32_bf16 v[24:27], v[92:95], a[140:143], v[24:27]
    v_mfma_f32_16x16x32_bf16 v[28:31], v[92:95], a[204:207], v[28:31]
    s_waitcnt vmcnt(13)
    v_mfma_f32_16x16x32_bf16 v[16:19], v[96:99], a[16:19], v[16:19]
    buffer_load_dwordx4 v[92:95], v1, s[48:51], s6 offen offset:1024 sc1
    v_mfma_f32_16x16x32_bf16 v[20:23], v[96:99], a[80:83], v[20:23]
    v_add_f32 v32, v32, v14
    v_mfma_f32_16x16x32_bf16 v[24:27], v[96:99], a[144:147], v[24:27]
    v_mfma_f32_16x16x32_bf16 v[28:31], v[96:99], a[208:211], v[28:31]
    s_waitcnt vmcnt(13)
    v_mfma_f32_16x16x32_bf16 v[16:19], v[100:103], a[20:23], v[16:19]
    buffer_load_dwordx4 v[96:99], v1, s[48:51], s6 offen offset:2048 sc1
    v_mfma_f32_16x16x32_bf16 v[20:23], v[100:103], a[84:87], v[20:23]
    v_add_f32 v33, v33, v14
    v_mfma_f32_16x16x32_bf16 v[24:27], v[100:103], a[148:151], v[24:27]
    v_mfma_f32_16x16x32_bf16 v[28:31], v[100:103], a[212:215], v[28:31]
    s_waitcnt lgkmcnt(0)
    s_barrier
    s_waitcnt vmcnt(13)
    v_mfma_f32_16x16x32_bf16 v[16:19], v[104:107], a[24:27], v[16:19]
    buffer_load_dwordx4 v[100:103], v1, s[48:51], s6 offen offset:3072 sc1
    v_mfma_f32_16x16x32_bf16 v[20:23], v[104:107], a[88:91], v[20:23]
    ds_read_b128 v[48:51], v123 offset:12288
    v_mfma_f32_16x16x32_bf16 v[24:27], v[104:107], a[152:155], v[24:27]
    ds_read_b128 v[52:55], v123 offset:13312
    v_mfma_f32_16x16x32_bf16 v[28:31], v[104:107], a[216:219], v[28:31]
    ds_read_b128 v[56:59], v123 offset:14336
    s_waitcnt vmcnt(13)
    v_mfma_f32_16x16x32_bf16 v[16:19], v[108:111], a[28:31], v[16:19]
    buffer_load_dwordx4 v[104:107], v124, s[48:51], s6 offen offset:0 sc1
    v_mfma_f32_16x16x32_bf16 v[20:23], v[108:111], a[92:95], v[20:23]
    v_add_f32 v34, v34, v14
    v_add_f32 v35, v35, v14
    v_mfma_f32_16x16x32_bf16 v[24:27], v[108:111], a[156:159], v[24:27]
    v_mfma_f32_16x16x32_bf16 v[28:31], v[108:111], a[220:223], v[28:31]
    s_waitcnt vmcnt(13)
    v_mfma_f32_16x16x32_bf16 v[16:19], v[112:115], a[32:35], v[16:19]
    buffer_load_dwordx4 v[108:111], v124, s[48:51], s6 offen offset:1024 sc1
    v_mfma_f32_16x16x32_bf16 v[20:23], v[112:115], a[96:99], v[20:23]
    s_waitcnt lgkmcnt(0)
    v_mfma_f32_16x16x32_bf16 v[24:27], v[112:115], a[160:163], v[24:27]
    v_add_f32 v48, v48, v32
    v_mfma_f32_16x16x32_bf16 v[28:31], v[112:115], a[224:227], v[28:31]
    v_add_f32 v49, v49, v33
    s_waitcnt vmcnt(12)
    v_mfma_f32_16x16x32_bf16 v[16:19], v[116:119], a[36:39], v[16:19]
    buffer_load_dwordx4 v[112:115], v124, s[48:51], s6 offen offset:2048 sc1
    v_mfma_f32_16x16x32_bf16 v[20:23], v[116:119], a[100:103], v[20:23]
    v_add_f32 v50, v50, v34
    v_mfma_f32_16x16x32_bf16 v[24:27], v[116:119], a[164:167], v[24:27]
    v_add_f32 v51, v51, v35
    v_mfma_f32_16x16x32_bf16 v[28:31], v[116:119], a[228:231], v[28:31]
    v_add_f32 v52, v52, v56
    s_waitcnt vmcnt(12)
    v_mfma_f32_16x16x32_bf16 v[16:19], v[64:67], a[40:43], v[16:19]
    buffer_load_dwordx4 v[116:119], v124, s[48:51], s6 offen offset:3072 sc1
    v_mfma_f32_16x16x32_bf16 v[20:23], v[64:67], a[104:107], v[20:23]
    v_add_f32 v53, v53, v57
    v_mfma_f32_16x16x32_bf16 v[24:27], v[64:67], a[168:171], v[24:27]
    v_add_f32 v54, v54, v58
    v_mfma_f32_16x16x32_bf16 v[28:31], v[64:67], a[232:235], v[28:31]
    v_add_f32 v55, v55, v59
    s_waitcnt vmcnt(12)
    v_mfma_f32_16x16x32_bf16 v[16:19], v[68:71], a[44:47], v[16:19]
    buffer_load_dwordx4 v[64:67], v125, s[48:51], s6 offen offset:0 sc1
    v_mfma_f32_16x16x32_bf16 v[20:23], v[68:71], a[108:111], v[20:23]
    v_add_f32 v148, v48, v52
    v_mfma_f32_16x16x32_bf16 v[24:27], v[68:71], a[172:175], v[24:27]
    v_add_f32 v149, v49, v53
    v_mfma_f32_16x16x32_bf16 v[28:31], v[68:71], a[236:239], v[28:31]
    v_add_f32 v150, v50, v54
    s_waitcnt vmcnt(12)
    v_mfma_f32_16x16x32_bf16 v[16:19], v[72:75], a[48:51], v[16:19]
    buffer_load_dwordx4 v[68:71], v125, s[48:51], s6 offen offset:1024 sc1
    v_mfma_f32_16x16x32_bf16 v[20:23], v[72:75], a[112:115], v[20:23]
    v_add_f32 v151, v51, v55
    v_mfma_f32_16x16x32_bf16 v[24:27], v[72:75], a[176:179], v[24:27]
    v_readfirstlane_b32 s79, v7
    s_mul_i32 s78, s53, 14
    s_cmp_lg_u32 s78, s79
    s_cbranch_scc1 L_g8_wait
L_g8_ok:
    v_mfma_f32_16x16x32_bf16 v[28:31], v[72:75], a[240:243], v[28:31]
    s_and_b32 s65, s9, -16
    s_add_u32 s65, s65, 12582912
    buffer_load_dwordx4 v[188:191], v1, s[48:51], s65 offen sc1
    s_waitcnt vmcnt(13)
    v_mfma_f32_16x16x32_bf16 v[16:19], v[76:79], a[52:55], v[16:19]
    buffer_load_dwordx4 v[72:75], v125, s[48:51], s6 offen offset:2048 sc1
    v_mfma_f32_16x16x32_bf16 v[20:23], v[76:79], a[116:119], v[20:23]
    s_add_u32 s65, s8, 12582912
    buffer_load_dwordx4 v[176:179], v1, s[48:51], s65 offen sc1
    v_mfma_f32_16x16x32_bf16 v[24:27], v[76:79], a[180:183], v[24:27]
    buffer_load_dwordx4 v[180:183], v1, s[48:51], s65 offen offset:1024 sc1
    v_mfma_f32_16x16x32_bf16 v[28:31], v[76:79], a[244:247], v[28:31]
    buffer_load_dwordx4 v[184:187], v1, s[48:51], s65 offen offset:2048 sc1
    s_waitcnt vmcnt(16)
    v_mfma_f32_16x16x32_bf16 v[16:19], v[80:83], a[56:59], v[16:19]
    buffer_load_dwordx4 v[76:79], v125, s[48:51], s6 offen offset:3072 sc1
    v_mfma_f32_16x16x32_bf16 v[20:23], v[80:83], a[120:123], v[20:23]
    s_add_u32 s8, s8, 16777216
    v_mfma_f32_16x16x32_bf16 v[24:27], v[80:83], a[184:187], v[24:27]
    s_mul_i32 s65, s5, 504
    s_add_u32 s9, s9, s65
    s_add_u32 s9, s9, 16777216
    v_lshlrev_b32 v210, 3, v0
    v_mfma_f32_16x16x32_bf16 v[28:31], v[80:83], a[248:251], v[28:31]
    s_waitcnt vmcnt(16)
    v_mfma_f32_16x16x32_bf16 v[16:19], v[84:87], a[60:63], v[16:19]
    buffer_load_dwordx4 v[80:83], v126, s[48:51], s6 offen offset:0 sc1
    v_mfma_f32_16x16x32_bf16 v[20:23], v[84:87], a[124:127], v[20:23]
    v_mfma_f32_16x16x32_bf16 v[24:27], v[84:87], a[188:191], v[24:27]
    v_mfma_f32_16x16x32_bf16 v[28:31], v[84:87], a[252:255], v[28:31]
    s_waitcnt vmcnt(16)
    v_mfma_f32_16x16x32_bf16 v[32:35], v[88:91], a[0:3], 0
    buffer_load_dwordx4 v[84:87], v126, s[48:51], s6 offen offset:1024 sc1
    v_mfma_f32_16x16x32_bf16 v[36:39], v[88:91], a[64:67], 0
    v_mfma_f32_16x16x32_bf16 v[40:43], v[88:91], a[128:131], 0
    v_mfma_f32_16x16x32_bf16 v[44:47], v[88:91], a[192:195], 0
    s_waitcnt vmcnt(16)
    v_mfma_f32_16x16x32_bf16 v[32:35], v[92:95], a[4:7], v[32:35]
    buffer_load_dwordx4 v[88:91], v126, s[48:51], s6 offen offset:2048 sc1
    v_mfma_f32_16x16x32_bf16 v[36:39], v[92:95], a[68:71], v[36:39]
    ds_write_b128 v120, v[20:23] offset:0
    v_mfma_f32_16x16x32_bf16 v[40:43], v[92:95], a[132:135], v[40:43]
    v_mfma_f32_16x16x32_bf16 v[44:47], v[92:95], a[196:199], v[44:47]
    s_waitcnt vmcnt(16)
    v_mfma_f32_16x16x32_bf16 v[32:35], v[96:99], a[8:11], v[32:35]
    buffer_load_dwordx4 v[92:95], v126, s[48:51], s6 offen offset:3072 sc1
    v_mfma_f32_16x16x32_bf16 v[36:39], v[96:99], a[72:75], v[36:39]
    ds_write_b128 v121, v[24:27] offset:0
    v_mfma_f32_16x16x32_bf16 v[40:43], v[96:99], a[136:139], v[40:43]
    v_mfma_f32_16x16x32_bf16 v[44:47], v[96:99], a[200:203], v[44:47]
    s_waitcnt vmcnt(16)
    v_mfma_f32_16x16x32_bf16 v[32:35], v[100:103], a[12:15], v[32:35]
    s_add_u32 s6, s6, 65536
    buffer_load_dwordx4 v[96:99], v1, s[48:51], s6 offen offset:0 sc1
    v_mfma_f32_16x16x32_bf16 v[36:39], v[100:103], a[76:79], v[36:39]
    ds_write_b128 v122, v[28:31] offset:0
    v_mfma_f32_16x16x32_bf16 v[40:43], v[100:103], a[140:143], v[40:43]
    v_mfma_f32_16x16x32_bf16 v[44:47], v[100:103], a[204:207], v[44:47]
    s_waitcnt vmcnt(16)
    v_mfma_f32_16x16x32_bf16 v[32:35], v[104:107], a[16:19], v[32:35]
    buffer_load_dwordx4 v[100:103], v1, s[48:51], s6 offen offset:1024 sc1
    v_mfma_f32_16x16x32_bf16 v[36:39], v[104:107], a[80:83], v[36:39]
    v_add_f32 v16, v16, v14
    v_mfma_f32_16x16x32_bf16 v[40:43], v[104:107], a[144:147], v[40:43]
    v_mfma_f32_16x16x32_bf16 v[44:47], v[104:107], a[208:211], v[44:47]
    s_waitcnt vmcnt(16)
    v_mfma_f32_16x16x32_bf16 v[32:35], v[108:111], a[20:23], v[32:35]
    buffer_load_dwordx4 v[104:107], v1, s[48:51], s6 offen offset:2048 sc1
    v_mfma_f32_16x16x32_bf16 v[36:39], v[108:111], a[84:87], v[36:39]
    v_add_f32 v17, v17, v14
    v_mfma_f32_16x16x32_bf16 v[40:43], v[108:111], a[148:151], v[40:43]
    v_mfma_f32_16x16x32_bf16 v[44:47], v[108:111], a[212:215], v[44:47]
    s_waitcnt lgkmcnt(0)
    s_barrier
    s_waitcnt vmcnt(16)
    v_mfma_f32_16x16x32_bf16 v[32:35], v[112:115], a[24:27], v[32:35]
    buffer_load_dwordx4 v[108:111], v1, s[48:51], s6 offen offset:3072 sc1
    v_mfma_f32_16x16x32_bf16 v[36:39], v[112:115], a[88:91], v[36:39]
    ds_read_b128 v[48:51], v123 offset:0
    v_mfma_f32_16x16x32_bf16 v[40:43], v[112:115], a[152:155], v[40:43]
    ds_read_b128 v[52:55], v123 offset:1024
    v_mfma_f32_16x16x32_bf16 v[44:47], v[112:115], a[216:219], v[44:47]
    ds_read_b128 v[56:59], v123 offset:2048
    s_waitcnt vmcnt(16)
    v_mfma_f32_16x16x32_bf16 v[32:35], v[116:119], a[28:31], v[32:35]
    buffer_load_dwordx4 v[112:115], v124, s[48:51], s6 offen offset:0 sc1
    v_mfma_f32_16x16x32_bf16 v[36:39], v[116:119], a[92:95], v[36:39]
    v_add_f32 v18, v18, v14
    v_add_f32 v19, v19, v14
    v_mfma_f32_16x16x32_bf16 v[40:43], v[116:119], a[156:159], v[40:43]
    v_mfma_f32_16x16x32_bf16 v[44:47], v[116:119], a[220:223], v[44:47]
    s_waitcnt vmcnt(16)
    v_mfma_f32_16x16x32_bf16 v[32:35], v[64:67], a[32:35], v[32:35]
    buffer_load_dwordx4 v[116:119], v124, s[48:51], s6 offen offset:1024 sc1
    v_mfma_f32_16x16x32_bf16 v[36:39], v[64:67], a[96:99], v[36:39]
    s_waitcnt lgkmcnt(0)
    v_mfma_f32_16x16x32_bf16 v[40:43], v[64:67], a[160:163], v[40:43]
    v_add_f32 v48, v48, v16
    v_mfma_f32_16x16x32_bf16 v[44:47], v[64:67], a[224:227], v[44:47]
    v_add_f32 v49, v49, v17
    s_waitcnt vmcnt(16)
    v_mfma_f32_16x16x32_bf16 v[32:35], v[68:71], a[36:39], v[32:35]
    buffer_load_dwordx4 v[64:67], v124, s[48:51], s6 offen offset:2048 sc1
    v_mfma_f32_16x16x32_bf16 v[36:39], v[68:71], a[100:103], v[36:39]
    v_add_f32 v50, v50, v18
    v_mfma_f32_16x16x32_bf16 v[40:43], v[68:71], a[164:167], v[40:43]
    v_add_f32 v51, v51, v19
    v_mfma_f32_16x16x32_bf16 v[44:47], v[68:71], a[228:231], v[44:47]
    v_add_f32 v52, v52, v56
    s_waitcnt vmcnt(15)
    v_mfma_f32_16x16x32_bf16 v[32:35], v[72:75], a[40:43], v[32:35]
    buffer_load_dwordx4 v[68:71], v124, s[48:51], s6 offen offset:3072 sc1
    v_mfma_f32_16x16x32_bf16 v[36:39], v[72:75], a[104:107], v[36:39]
    v_add_f32 v53, v53, v57
    v_mfma_f32_16x16x32_bf16 v[40:43], v[72:75], a[168:171], v[40:43]
    v_add_f32 v54, v54, v58
    v_mfma_f32_16x16x32_bf16 v[44:47], v[72:75], a[232:235], v[44:47]
    v_add_f32 v55, v55, v59
    s_waitcnt vmcnt(12)
    v_mfma_f32_16x16x32_bf16 v[32:35], v[76:79], a[44:47], v[32:35]
    buffer_load_dwordx4 v[72:75], v125, s[48:51], s6 offen offset:0 sc1
    v_mfma_f32_16x16x32_bf16 v[36:39], v[76:79], a[108:111], v[36:39]
    v_add_f32 v48, v48, v52
    v_mfma_f32_16x16x32_bf16 v[40:43], v[76:79], a[172:175], v[40:43]
    v_add_f32 v49, v49, v53
    v_mfma_f32_16x16x32_bf16 v[44:47], v[76:79], a[236:239], v[44:47]
    v_add_f32 v50, v50, v54
    s_waitcnt vmcnt(12)
    v_mfma_f32_16x16x32_bf16 v[32:35], v[80:83], a[48:51], v[32:35]
    buffer_load_dwordx4 v[76:79], v125, s[48:51], s6 offen offset:1024 sc1
    v_mfma_f32_16x16x32_bf16 v[36:39], v[80:83], a[112:115], v[36:39]
    v_add_f32 v51, v51, v55
    v_mfma_f32_16x16x32_bf16 v[40:43], v[80:83], a[176:179], v[40:43]
    v_lshlrev_b32 v206, 16, v178
    v_mfma_f32_16x16x32_bf16 v[44:47], v[80:83], a[240:243], v[44:47]
    v_and_b32 v207, s74, v178
    s_waitcnt vmcnt(12)
    v_mfma_f32_16x16x32_bf16 v[32:35], v[84:87], a[52:55], v[32:35]
    buffer_load_dwordx4 v[80:83], v125, s[48:51], s6 offen offset:2048 sc1
    v_mfma_f32_16x16x32_bf16 v[36:39], v[84:87], a[116:119], v[36:39]
    v_lshlrev_b32 v208, 16, v179
    v_mfma_f32_16x16x32_bf16 v[40:43], v[84:87], a[180:183], v[40:43]
    v_and_b32 v209, s74, v179
    v_mfma_f32_16x16x32_bf16 v[44:47], v[84:87], a[244:247], v[44:47]
    v_mul_f32 v48, v48, v206
    s_waitcnt vmcnt(12)
    v_mfma_f32_16x16x32_bf16 v[32:35], v[88:91], a[56:59], v[32:35]
    buffer_load_dwordx4 v[84:87], v125, s[48:51], s6 offen offset:3072 sc1
    v_mfma_f32_16x16x32_bf16 v[36:39], v[88:91], a[120:123], v[36:39]
    v_mul_f32 v49, v49, v207
    v_mfma_f32_16x16x32_bf16 v[40:43], v[88:91], a[184:187], v[40:43]
    v_mul_f32 v50, v50, v208
    v_mfma_f32_16x16x32_bf16 v[44:47], v[88:91], a[248:251], v[44:47]
    v_mul_f32 v51, v51, v209
    s_waitcnt vmcnt(12)
    v_mfma_f32_16x16x32_bf16 v[32:35], v[92:95], a[60:63], v[32:35]
    buffer_load_dwordx4 v[88:91], v126, s[48:51], s6 offen offset:0 sc1
    v_mfma_f32_16x16x32_bf16 v[36:39], v[92:95], a[124:127], v[36:39]
    v_cvt_pk_bf16_f32 v222, v48, v49
    v_mfma_f32_16x16x32_bf16 v[40:43], v[92:95], a[188:191], v[40:43]
    v_cvt_pk_bf16_f32 v223, v50, v51
    v_mfma_f32_16x16x32_bf16 v[44:47], v[92:95], a[252:255], v[44:47]
    s_waitcnt vmcnt(12)
    v_mfma_f32_16x16x32_bf16 v[16:19], v[96:99], a[0:3], 0
    buffer_load_dwordx4 v[92:95], v126, s[48:51], s6 offen offset:1024 sc1
    v_mfma_f32_16x16x32_bf16 v[20:23], v[96:99], a[64:67], 0
    v_mfma_f32_16x16x32_bf16 v[24:27], v[96:99], a[128:131], 0
    s_cmp_eq_u32 s5, 1
    s_cselect_b64 vcc, -1, 0
    v_cndmask_b32 v188, v188, v190, vcc
    v_cndmask_b32 v189, v189, v191, vcc
    v_lshlrev_b32 v206, 16, v188
    v_mfma_f32_16x16x32_bf16 v[28:31], v[96:99], a[192:195], 0
    v_and_b32 v207, s74, v188
    s_waitcnt vmcnt(12)
    v_mfma_f32_16x16x32_bf16 v[16:19], v[100:103], a[4:7], v[16:19]
    buffer_load_dwordx4 v[96:99], v126, s[48:51], s6 offen offset:2048 sc1
    v_mfma_f32_16x16x32_bf16 v[20:23], v[100:103], a[68:71], v[20:23]
    ds_write_b128 v120, v[36:39] offset:12288
    v_mfma_f32_16x16x32_bf16 v[24:27], v[100:103], a[132:135], v[24:27]
    v_lshlrev_b32 v208, 16, v189
    v_mfma_f32_16x16x32_bf16 v[28:31], v[100:103], a[196:199], v[28:31]
    v_and_b32 v209, s74, v189
    s_waitcnt vmcnt(12)
    v_mfma_f32_16x16x32_bf16 v[16:19], v[104:107], a[8:11], v[16:19]
    buffer_load_dwordx4 v[100:103], v126, s[48:51], s6 offen offset:3072 sc1
    v_mfma_f32_16x16x32_bf16 v[20:23], v[104:107], a[72:75], v[20:23]
    ds_write_b128 v121, v[40:43] offset:12288
    v_mfma_f32_16x16x32_bf16 v[24:27], v[104:107], a[136:139], v[24:27]
    v_mul_f32 v144, v144, v206
    v_mfma_f32_16x16x32_bf16 v[28:31], v[104:107], a[200:203], v[28:31]
    v_mul_f32 v145, v145, v207
    s_waitcnt vmcnt(12)
    v_mfma_f32_16x16x32_bf16 v[16:19], v[108:111], a[12:15], v[16:19]
    s_add_u32 s6, s6, 65536
    buffer_load_dwordx4 v[104:107], v1, s[48:51], s6 offen offset:0 sc1
    v_mfma_f32_16x16x32_bf16 v[20:23], v[108:111], a[76:79], v[20:23]
    ds_write_b128 v122, v[44:47] offset:12288
    v_mfma_f32_16x16x32_bf16 v[24:27], v[108:111], a[140:143], v[24:27]
    v_mul_f32 v146, v146, v208
    v_mfma_f32_16x16x32_bf16 v[28:31], v[108:111], a[204:207], v[28:31]
    v_mul_f32 v147, v147, v209
    s_waitcnt vmcnt(12)
    v_mfma_f32_16x16x32_bf16 v[16:19], v[112:115], a[16:19], v[16:19]
    buffer_load_dwordx4 v[108:111], v1, s[48:51], s6 offen offset:1024 sc1
    v_mfma_f32_16x16x32_bf16 v[20:23], v[112:115], a[80:83], v[20:23]
    v_add_f32 v32, v32, v14
    v_mfma_f32_16x16x32_bf16 v[24:27], v[112:115], a[144:147], v[24:27]
    v_cvt_pk_bf16_f32 v232, v144, v145
    v_mfma_f32_16x16x32_bf16 v[28:31], v[112:115], a[208:211], v[28:31]
    v_cvt_pk_bf16_f32 v233, v146, v147
    s_waitcnt vmcnt(12)
    v_mfma_f32_16x16x32_bf16 v[16:19], v[116:119], a[20:23], v[16:19]
    buffer_load_dwordx4 v[112:115], v1, s[48:51], s6 offen offset:2048 sc1
    v_mfma_f32_16x16x32_bf16 v[20:23], v[116:119], a[84:87], v[20:23]
    v_add_f32 v33, v33, v14
    v_mfma_f32_16x16x32_bf16 v[24:27], v[116:119], a[148:151], v[24:27]
    v_permlane32_swap_b32 v232, v234
    v_mfma_f32_16x16x32_bf16 v[28:31], v[116:119], a[212:215], v[28:31]
    s_waitcnt lgkmcnt(0)
    s_barrier
    v_permlane32_swap_b32 v233, v235
    s_waitcnt vmcnt(12)
    v_mfma_f32_16x16x32_bf16 v[16:19], v[64:67], a[24:27], v[16:19]
    buffer_load_dwordx4 v[116:119], v1, s[48:51], s6 offen offset:3072 sc1
    v_mfma_f32_16x16x32_bf16 v[20:23], v[64:67], a[88:91], v[20:23]
    ds_read_b128 v[48:51], v123 offset:12288
    v_mfma_f32_16x16x32_bf16 v[24:27], v[64:67], a[152:155], v[24:27]
    ds_read_b128 v[52:55], v123 offset:13312
    v_mfma_f32_16x16x32_bf16 v[28:31], v[64:67], a[216:219], v[28:31]
    ds_read_b128 v[56:59], v123 offset:14336
    s_waitcnt vmcnt(12)
    v_mfma_f32_16x16x32_bf16 v[16:19], v[68:71], a[28:31], v[16:19]
    buffer_load_dwordx4 v[64:67], v124, s[48:51], s6 offen offset:0 sc1
    v_mfma_f32_16x16x32_bf16 v[20:23], v[68:71], a[92:95], v[20:23]
    v_add_f32 v34, v34, v14
    v_add_f32 v35, v35, v14
    v_mfma_f32_16x16x32_bf16 v[24:27], v[68:71], a[156:159], v[24:27]
    v_mfma_f32_16x16x32_bf16 v[28:31], v[68:71], a[220:223], v[28:31]
    s_waitcnt vmcnt(12)
    v_mfma_f32_16x16x32_bf16 v[16:19], v[72:75], a[32:35], v[16:19]
    buffer_load_dwordx4 v[68:71], v124, s[48:51], s6 offen offset:1024 sc1
    v_mfma_f32_16x16x32_bf16 v[20:23], v[72:75], a[96:99], v[20:23]
    s_waitcnt lgkmcnt(0)
    v_mfma_f32_16x16x32_bf16 v[24:27], v[72:75], a[160:163], v[24:27]
    v_add_f32 v48, v48, v32
    v_mfma_f32_16x16x32_bf16 v[28:31], v[72:75], a[224:227], v[28:31]
    v_add_f32 v49, v49, v33
    s_waitcnt vmcnt(12)
    v_mfma_f32_16x16x32_bf16 v[16:19], v[76:79], a[36:39], v[16:19]
    buffer_load_dwordx4 v[72:75], v124, s[48:51], s6 offen offset:2048 sc1
    v_mfma_f32_16x16x32_bf16 v[20:23], v[76:79], a[100:103], v[20:23]
    v_add_f32 v50, v50, v34
    v_mfma_f32_16x16x32_bf16 v[24:27], v[76:79], a[164:167], v[24:27]
    v_add_f32 v51, v51, v35
    v_mfma_f32_16x16x32_bf16 v[28:31], v[76:79], a[228:231], v[28:31]
    v_add_f32 v52, v52, v56
    s_waitcnt vmcnt(12)
    v_mfma_f32_16x16x32_bf16 v[16:19], v[80:83], a[40:43], v[16:19]
    buffer_load_dwordx4 v[76:79], v124, s[48:51], s6 offen offset:3072 sc1
    v_mfma_f32_16x16x32_bf16 v[20:23], v[80:83], a[104:107], v[20:23]
    v_add_f32 v53, v53, v57
    v_mfma_f32_16x16x32_bf16 v[24:27], v[80:83], a[168:171], v[24:27]
    v_add_f32 v54, v54, v58
    v_mfma_f32_16x16x32_bf16 v[28:31], v[80:83], a[232:235], v[28:31]
    v_add_f32 v55, v55, v59
    s_waitcnt vmcnt(12)
    v_mfma_f32_16x16x32_bf16 v[16:19], v[84:87], a[44:47], v[16:19]
    buffer_load_dwordx4 v[80:83], v125, s[48:51], s6 offen offset:0 sc1
    v_mfma_f32_16x16x32_bf16 v[20:23], v[84:87], a[108:111], v[20:23]
    v_add_f32 v48, v48, v52
    v_mfma_f32_16x16x32_bf16 v[24:27], v[84:87], a[172:175], v[24:27]
    v_add_f32 v49, v49, v53
    v_mfma_f32_16x16x32_bf16 v[28:31], v[84:87], a[236:239], v[28:31]
    v_add_f32 v50, v50, v54
    s_waitcnt vmcnt(12)
    v_mfma_f32_16x16x32_bf16 v[16:19], v[88:91], a[48:51], v[16:19]
    buffer_load_dwordx4 v[84:87], v125, s[48:51], s6 offen offset:1024 sc1
    v_mfma_f32_16x16x32_bf16 v[20:23], v[88:91], a[112:115], v[20:23]
    v_add_f32 v51, v51, v55
    v_mfma_f32_16x16x32_bf16 v[24:27], v[88:91], a[176:179], v[24:27]
    v_lshlrev_b32 v206, 16, v180
    v_mfma_f32_16x16x32_bf16 v[28:31], v[88:91], a[240:243], v[28:31]
    v_and_b32 v207, s74, v180
    s_waitcnt vmcnt(12)
    v_mfma_f32_16x16x32_bf16 v[16:19], v[92:95], a[52:55], v[16:19]
    buffer_load_dwordx4 v[88:91], v125, s[48:51], s6 offen offset:2048 sc1
    v_mfma_f32_16x16x32_bf16 v[20:23], v[92:95], a[116:119], v[20:23]
    v_lshlrev_b32 v208, 16, v181
    v_mfma_f32_16x16x32_bf16 v[24:27], v[92:95], a[180:183], v[24:27]
    v_and_b32 v209, s74, v181
    v_mfma_f32_16x16x32_bf16 v[28:31], v[92:95], a[244:247], v[28:31]
    v_mul_f32 v48, v48, v206
    s_waitcnt vmcnt(12)
    v_mfma_f32_16x16x32_bf16 v[16:19], v[96:99], a[56:59], v[16:19]
    buffer_load_dwordx4 v[92:95], v125, s[48:51], s6 offen offset:3072 sc1
    v_mfma_f32_16x16x32_bf16 v[20:23], v[96:99], a[120:123], v[20:23]
    v_mul_f32 v49, v49, v207
    v_mfma_f32_16x16x32_bf16 v[24:27], v[96:99], a[184:187], v[24:27]
    v_mul_f32 v50, v50, v208
    v_mfma_f32_16x16x32_bf16 v[28:31], v[96:99], a[248:251], v[28:31]
    v_mul_f32_e64 v51, v51, v209
    s_waitcnt vmcnt(12)
    v_mfma_f32_16x16x32_bf16 v[16:19], v[100:103], a[60:63], v[16:19]
    buffer_load_dwordx4 v[96:99], v126, s[48:51], s6 offen offset:0 sc1
    v_mfma_f32_16x16x32_bf16 v[20:23], v[100:103], a[124:127], v[20:23]
    v_cvt_pk_bf16_f32 v224, v48, v49
    v_mfma_f32_16x16x32_bf16 v[24:27], v[100:103], a[188:191], v[24:27]
    v_cvt_pk_bf16_f32 v225, v50, v51
    v_mfma_f32_16x16x32_bf16 v[28:31], v[100:103], a[252:255], v[28:31]
    s_waitcnt vmcnt(12)
    v_mfma_f32_16x16x32_bf16 v[32:35], v[104:107], a[0:3], 0
    buffer_load_dwordx4 v[100:103], v126, s[48:51], s6 offen offset:1024 sc1
    v_mfma_f32_16x16x32_bf16 v[36:39], v[104:107], a[64:67], 0
    v_mfma_f32_16x16x32_bf16 v[40:43], v[104:107], a[128:131], 0
    v_lshlrev_b32 v206, 16, v176
    v_mfma_f32_16x16x32_bf16 v[44:47], v[104:107], a[192:195], 0
    v_and_b32 v207, s74, v176
    s_waitcnt vmcnt(12)
    v_mfma_f32_16x16x32_bf16 v[32:35], v[108:111], a[4:7], v[32:35]
    buffer_load_dwordx4 v[104:107], v126, s[48:51], s6 offen offset:2048 sc1
    v_mfma_f32_16x16x32_bf16 v[36:39], v[108:111], a[68:71], v[36:39]
    ds_write_b128 v120, v[20:23] offset:0
    v_mfma_f32_16x16x32_bf16 v[40:43], v[108:111], a[132:135], v[40:43]
    v_lshlrev_b32 v208, 16, v177
    v_mfma_f32_16x16x32_bf16 v[44:47], v[108:111], a[196:199], v[44:47]
    v_and_b32 v209, s74, v177
    s_waitcnt vmcnt(12)
    v_mfma_f32_16x16x32_bf16 v[32:35], v[112:115], a[8:11], v[32:35]
    buffer_load_dwordx4 v[108:111], v126, s[48:51], s6 offen offset:3072 sc1
    v_mfma_f32_16x16x32_bf16 v[36:39], v[112:115], a[72:75], v[36:39]
    ds_write_b128 v121, v[24:27] offset:0
    v_mfma_f32_16x16x32_bf16 v[40:43], v[112:115], a[136:139], v[40:43]
    v_mul_f32 v148, v148, v206
    v_mfma_f32_16x16x32_bf16 v[44:47], v[112:115], a[200:203], v[44:47]
    v_mul_f32 v149, v149, v207
    s_waitcnt vmcnt(12)
    v_mfma_f32_16x16x32_bf16 v[32:35], v[116:119], a[12:15], v[32:35]
    s_add_u32 s6, s6, 65536
    buffer_load_dwordx4 v[112:115], v1, s[48:51], s6 offen offset:0 sc1
    v_mfma_f32_16x16x32_bf16 v[36:39], v[116:119], a[76:79], v[36:39]
    ds_write_b128 v122, v[28:31] offset:0
    v_mfma_f32_16x16x32_bf16 v[40:43], v[116:119], a[140:143], v[40:43]
    v_mul_f32 v150, v150, v208
    v_mfma_f32_16x16x32_bf16 v[44:47], v[116:119], a[204:207], v[44:47]
    v_mul_f32 v151, v151, v209
    s_waitcnt vmcnt(12)
    v_mfma_f32_16x16x32_bf16 v[32:35], v[64:67], a[16:19], v[32:35]
    buffer_load_dwordx4 v[116:119], v1, s[48:51], s6 offen offset:1024 sc1
    v_mfma_f32_16x16x32_bf16 v[36:39], v[64:67], a[80:83], v[36:39]
    v_add_f32 v16, v16, v14
    v_mfma_f32_16x16x32_bf16 v[40:43], v[64:67], a[144:147], v[40:43]
    v_cvt_pk_bf16_f32 v220, v148, v149
    v_mfma_f32_16x16x32_bf16 v[44:47], v[64:67], a[208:211], v[44:47]
    v_cvt_pk_bf16_f32 v221, v150, v151
    s_waitcnt vmcnt(12)
    v_mfma_f32_16x16x32_bf16 v[32:35], v[68:71], a[20:23], v[32:35]
    buffer_load_dwordx4 v[64:67], v1, s[48:51], s6 offen offset:2048 sc1
    v_mfma_f32_16x16x32_bf16 v[36:39], v[68:71], a[84:87], v[36:39]
    v_add_f32 v17, v17, v14
    v_mfma_f32_16x16x32_bf16 v[40:43], v[68:71], a[148:151], v[40:43]
    v_mfma_f32_16x16x32_bf16 v[44:47], v[68:71], a[212:215], v[44:47]
    s_waitcnt lgkmcnt(0)
    s_branch L_page7
.p2align 12
L_stub7:
    s_branch L_walked
L_page7:
    s_barrier
    s_waitcnt vmcnt(12)
    v_mfma_f32_16x16x32_bf16 v[32:35], v[72:75], a[24:27], v[32:35]
    buffer_load_dwordx4 v[68:71], v1, s[48:51], s6 offen offset:3072 sc1
    v_mfma_f32_16x16x32_bf16 v[36:39], v[72:75], a[88:91], v[36:39]
    ds_read_b128 v[48:51], v123 offset:0
    v_mfma_f32_16x16x32_bf16 v[40:43], v[72:75], a[152:155], v[40:43]
    ds_read_b128 v[52:55], v123 offset:1024
    v_mfma_f32_16x16x32_bf16 v[44:47], v[72:75], a[216:219], v[44:47]
    ds_read_b128 v[56:59], v123 offset:2048
    s_waitcnt vmcnt(12)
    v_mfma_f32_16x16x32_bf16 v[32:35], v[76:79], a[28:31], v[32:35]
    buffer_load_dwordx4 v[72:75], v124, s[48:51], s6 offen offset:0 sc1
    v_mfma_f32_16x16x32_bf16 v[36:39], v[76:79], a[92:95], v[36:39]
    v_add_f32 v18, v18, v14
    v_add_f32 v19, v19, v14
    v_mfma_f32_16x16x32_bf16 v[40:43], v[76:79], a[156:159], v[40:43]
    v_mfma_f32_16x16x32_bf16 v[44:47], v[76:79], a[220:223], v[44:47]
    s_waitcnt vmcnt(12)
    v_mfma_f32_16x16x32_bf16 v[32:35], v[80:83], a[32:35], v[32:35]
    buffer_load_dwordx4 v[76:79], v124, s[48:51], s6 offen offset:1024 sc1
    v_mfma_f32_16x16x32_bf16 v[36:39], v[80:83], a[96:99], v[36:39]
    s_waitcnt lgkmcnt(0)
    v_mfma_f32_16x16x32_bf16 v[40:43], v[80:83], a[160:163], v[40:43]
    v_add_f32 v48, v48, v16
    v_mfma_f32_16x16x32_bf16 v[44:47], v[80:83], a[224:227], v[44:47]
    v_add_f32 v49, v49, v17
    s_waitcnt vmcnt(12)
    v_mfma_f32_16x16x32_bf16 v[32:35], v[84:87], a[36:39], v[32:35]
    buffer_load_dwordx4 v[80:83], v124, s[48:51], s6 offen offset:2048 sc1
    v_mfma_f32_16x16x32_bf16 v[36:39], v[84:87], a[100:103], v[36:39]
    v_add_f32 v50, v50, v18
    v_mfma_f32_16x16x32_bf16 v[40:43], v[84:87], a[164:167], v[40:43]
    v_add_f32 v51, v51, v19
    v_mfma_f32_16x16x32_bf16 v[44:47], v[84:87], a[228:231], v[44:47]
    v_add_f32 v52, v52, v56
    s_waitcnt vmcnt(12)
    v_mfma_f32_16x16x32_bf16 v[32:35], v[88:91], a[40:43], v[32:35]
    buffer_load_dwordx4 v[84:87], v124, s[48:51], s6 offen offset:3072 sc1
    v_mfma_f32_16x16x32_bf16 v[36:39], v[88:91], a[104:107], v[36:39]
    v_add_f32 v53, v53, v57
    v_mfma_f32_16x16x32_bf16 v[40:43], v[88:91], a[168:171], v[40:43]
    v_add_f32 v54, v54, v58
    v_mfma_f32_16x16x32_bf16 v[44:47], v[88:91], a[232:235], v[44:47]
    v_add_f32 v55, v55, v59
    s_waitcnt vmcnt(12)
    v_mfma_f32_16x16x32_bf16 v[32:35], v[92:95], a[44:47], v[32:35]
    buffer_load_dwordx4 v[88:91], v125, s[48:51], s6 offen offset:0 sc1
    v_mfma_f32_16x16x32_bf16 v[36:39], v[92:95], a[108:111], v[36:39]
    v_add_f32 v48, v48, v52
    v_mfma_f32_16x16x32_bf16 v[40:43], v[92:95], a[172:175], v[40:43]
    v_add_f32 v49, v49, v53
    v_mfma_f32_16x16x32_bf16 v[44:47], v[92:95], a[236:239], v[44:47]
    v_add_f32 v50, v50, v54
    s_waitcnt vmcnt(12)
    v_mfma_f32_16x16x32_bf16 v[32:35], v[96:99], a[48:51], v[32:35]
    buffer_load_dwordx4 v[92:95], v125, s[48:51], s6 offen offset:1024 sc1
    v_mfma_f32_16x16x32_bf16 v[36:39], v[96:99], a[112:115], v[36:39]
    v_add_f32 v51, v51, v55
    v_mfma_f32_16x16x32_bf16 v[40:43], v[96:99], a[176:179], v[40:43]
    v_lshlrev_b32 v206, 16, v182
    v_mfma_f32_16x16x32_bf16 v[44:47], v[96:99], a[240:243], v[44:47]
    v_and_b32 v207, s74, v182
    s_waitcnt vmcnt(12)
    v_mfma_f32_16x16x32_bf16 v[32:35], v[100:103], a[52:55], v[32:35]
    buffer_load_dwordx4 v[96:99], v125, s[48:51], s6 offen offset:2048 sc1
    v_mfma_f32_16x16x32_bf16 v[36:39], v[100:103], a[116:119], v[36:39]
    v_lshlrev_b32 v208, 16, v183
    v_mfma_f32_16x16x32_bf16 v[40:43], v[100:103], a[180:183], v[40:43]
    v_and_b32 v209, s74, v183
    v_mfma_f32_16x16x32_bf16 v[44:47], v[100:103], a[244:247], v[44:47]
    v_mul_f32 v48, v48, v206
    s_waitcnt vmcnt(12)
    v_mfma_f32_16x16x32_bf16 v[32:35], v[104:107], a[56:59], v[32:35]
    buffer_load_dwordx4 v[100:103], v125, s[48:51], s6 offen offset:3072 sc1
    v_mfma_f32_16x16x32_bf16 v[36:39], v[104:107], a[120:123], v[36:39]
    v_mul_f32 v49, v49, v207
    v_mfma_f32_16x16x32_bf16 v[40:43], v[104:107], a[184:187], v[40:43]
    v_mul_f32 v50, v50, v208
    v_mfma_f32_16x16x32_bf16 v[44:47], v[104:107], a[248:251], v[44:47]
    v_mul_f32_e64 v51, v51, v209
    s_waitcnt vmcnt(12)
    v_mfma_f32_16x16x32_bf16 v[32:35], v[108:111], a[60:63], v[32:35]
    buffer_load_dwordx4 v[104:107], v126, s[48:51], s6 offen offset:0 sc1
    v_mfma_f32_16x16x32_bf16 v[36:39], v[108:111], a[124:127], v[36:39]
    v_cvt_pk_bf16_f32 v226, v48, v49
    v_mfma_f32_16x16x32_bf16 v[40:43], v[108:111], a[188:191], v[40:43]
    v_cvt_pk_bf16_f32 v227, v50, v51
    v_mfma_f32_16x16x32_bf16 v[44:47], v[108:111], a[252:255], v[44:47]
    s_waitcnt vmcnt(12)
    v_mfma_f32_16x16x32_bf16 v[16:19], v[112:115], a[0:3], 0
    buffer_load_dwordx4 v[108:111], v126, s[48:51], s6 offen offset:1024 sc1
    v_mfma_f32_16x16x32_bf16 v[20:23], v[112:115], a[64:67], 0
    v_mfma_f32_16x16x32_bf16 v[24:27], v[112:115], a[128:131], 0
    v_mfma_f32_16x16x32_bf16 v[28:31], v[112:115], a[192:195], 0
    s_waitcnt vmcnt(12)
    v_mfma_f32_16x16x32_bf16 v[16:19], v[116:119], a[4:7], v[16:19]
    buffer_load_dwordx4 v[112:115], v126, s[48:51], s6 offen offset:2048 sc1
    v_mfma_f32_16x16x32_bf16 v[20:23], v[116:119], a[68:71], v[20:23]
    ds_write_b128 v120, v[36:39] offset:12288
    v_mfma_f32_16x16x32_bf16 v[24:27], v[116:119], a[132:135], v[24:27]
    v_mfma_f32_16x16x32_bf16 v[28:31], v[116:119], a[196:199], v[28:31]
    s_waitcnt vmcnt(12)
    v_mfma_f32_16x16x32_bf16 v[16:19], v[64:67], a[8:11], v[16:19]
    buffer_load_dwordx4 v[116:119], v126, s[48:51], s6 offen offset:3072 sc1
    v_mfma_f32_16x16x32_bf16 v[20:23], v[64:67], a[72:75], v[20:23]
    ds_write_b128 v121, v[40:43] offset:12288
    v_mfma_f32_16x16x32_bf16 v[24:27], v[64:67], a[136:139], v[24:27]
    v_mfma_f32_16x16x32_bf16 v[28:31], v[64:67], a[200:203], v[28:31]
    s_waitcnt vmcnt(12)
    v_mfma_f32_16x16x32_bf16 v[16:19], v[68:71], a[12:15], v[16:19]
    v_mfma_f32_16x16x32_bf16 v[20:23], v[68:71], a[76:79], v[20:23]
    ds_write_b128 v122, v[44:47] offset:12288
    v_mfma_f32_16x16x32_bf16 v[24:27], v[68:71], a[140:143], v[24:27]
    v_mfma_f32_16x16x32_bf16 v[28:31], v[68:71], a[204:207], v[28:31]
    s_waitcnt vmcnt(11)
    v_mfma_f32_16x16x32_bf16 v[16:19], v[72:75], a[16:19], v[16:19]
    v_mfma_f32_16x16x32_bf16 v[20:23], v[72:75], a[80:83], v[20:23]
    v_add_f32 v32, v32, v14
    v_mfma_f32_16x16x32_bf16 v[24:27], v[72:75], a[144:147], v[24:27]
    v_mfma_f32_16x16x32_bf16 v[28:31], v[72:75], a[208:211], v[28:31]
    s_waitcnt vmcnt(10)
    v_mfma_f32_16x16x32_bf16 v[16:19], v[76:79], a[20:23], v[16:19]
    v_mfma_f32_16x16x32_bf16 v[20:23], v[76:79], a[84:87], v[20:23]
    v_add_f32 v33, v33, v14
    v_mfma_f32_16x16x32_bf16 v[24:27], v[76:79], a[148:151], v[24:27]
    v_mfma_f32_16x16x32_bf16 v[28:31], v[76:79], a[212:215], v[28:31]
    s_waitcnt lgkmcnt(0)
    s_barrier
    s_waitcnt vmcnt(9)
    v_mfma_f32_16x16x32_bf16 v[16:19], v[80:83], a[24:27], v[16:19]
    v_mfma_f32_16x16x32_bf16 v[20:23], v[80:83], a[88:91], v[20:23]
    ds_read_b128 v[48:51], v123 offset:12288
    v_mfma_f32_16x16x32_bf16 v[24:27], v[80:83], a[152:155], v[24:27]
    ds_read_b128 v[52:55], v123 offset:13312
    v_mfma_f32_16x16x32_bf16 v[28:31], v[80:83], a[216:219], v[28:31]
    ds_read_b128 v[56:59], v123 offset:14336
    s_waitcnt vmcnt(8)
    v_mfma_f32_16x16x32_bf16 v[16:19], v[84:87], a[28:31], v[16:19]
    v_mfma_f32_16x16x32_bf16 v[20:23], v[84:87], a[92:95], v[20:23]
    v_add_f32 v34, v34, v14
    v_add_f32 v35, v35, v14
    v_mfma_f32_16x16x32_bf16 v[24:27], v[84:87], a[156:159], v[24:27]
    v_mfma_f32_16x16x32_bf16 v[28:31], v[84:87], a[220:223], v[28:31]
    s_waitcnt vmcnt(7)
    v_mfma_f32_16x16x32_bf16 v[16:19], v[88:91], a[32:35], v[16:19]
    buffer_store_dwordx4 v[220:223], v1, s[48:51], s8 offen offset:0 sc1
    v_mfma_f32_16x16x32_bf16 v[20:23], v[88:91], a[96:99], v[20:23]
    s_waitcnt lgkmcnt(0)
    v_mfma_f32_16x16x32_bf16 v[24:27], v[88:91], a[160:163], v[24:27]
    v_add_f32 v48, v48, v32
    v_mfma_f32_16x16x32_bf16 v[28:31], v[88:91], a[224:227], v[28:31]
    v_add_f32 v49, v49, v33
    s_waitcnt vmcnt(7)
    v_mfma_f32_16x16x32_bf16 v[16:19], v[92:95], a[36:39], v[16:19]
    v_mfma_f32_16x16x32_bf16 v[20:23], v[92:95], a[100:103], v[20:23]
    v_add_f32 v50, v50, v34
    v_mfma_f32_16x16x32_bf16 v[24:27], v[92:95], a[164:167], v[24:27]
    v_add_f32 v51, v51, v35
    v_mfma_f32_16x16x32_bf16 v[28:31], v[92:95], a[228:231], v[28:31]
    v_add_f32 v52, v52, v56
    s_waitcnt vmcnt(6)
    v_mfma_f32_16x16x32_bf16 v[16:19], v[96:99], a[40:43], v[16:19]
    s_mov_b32 exec_hi, 0
    buffer_store_dwordx4 v[232:235], v1, s[48:51], s9 offen sc1
    s_mov_b32 exec_hi, -1
    v_mfma_f32_16x16x32_bf16 v[20:23], v[96:99], a[104:107], v[20:23]
    v_add_f32 v53, v53, v57
    v_mfma_f32_16x16x32_bf16 v[24:27], v[96:99], a[168:171], v[24:27]
    v_add_f32 v54, v54, v58
    v_mfma_f32_16x16x32_bf16 v[28:31], v[96:99], a[232:235], v[28:31]
    v_add_f32 v55, v55, v59
    s_waitcnt vmcnt(6)
    v_mfma_f32_16x16x32_bf16 v[16:19], v[100:103], a[44:47], v[16:19]
    v_mfma_f32_16x16x32_bf16 v[20:23], v[100:103], a[108:111], v[20:23]
    v_add_f32 v48, v48, v52
    v_mfma_f32_16x16x32_bf16 v[24:27], v[100:103], a[172:175], v[24:27]
    v_add_f32 v49, v49, v53
    v_mfma_f32_16x16x32_bf16 v[28:31], v[100:103], a[236:239], v[28:31]
    v_add_f32 v50, v50, v54
    s_waitcnt vmcnt(5)
    v_mfma_f32_16x16x32_bf16 v[16:19], v[104:107], a[48:51], v[16:19]
    buffer_store_dwordx4 v[224:227], v1, s[48:51], s8 offen offset:1024 sc1
    v_mfma_f32_16x16x32_bf16 v[20:23], v[104:107], a[112:115], v[20:23]
    v_add_f32 v51, v51, v55
    v_mfma_f32_16x16x32_bf16 v[24:27], v[104:107], a[176:179], v[24:27]
    v_lshlrev_b32 v206, 16, v184
    v_mfma_f32_16x16x32_bf16 v[28:31], v[104:107], a[240:243], v[28:31]
    v_and_b32 v207, s74, v184
    s_waitcnt vmcnt(5)
    v_mfma_f32_16x16x32_bf16 v[16:19], v[108:111], a[52:55], v[16:19]
    v_mfma_f32_16x16x32_bf16 v[20:23], v[108:111], a[116:119], v[20:23]
    v_lshlrev_b32 v208, 16, v185
    v_mfma_f32_16x16x32_bf16 v[24:27], v[108:111], a[180:183], v[24:27]
    v_and_b32 v209, s74, v185
    v_mfma_f32_16x16x32_bf16 v[28:31], v[108:111], a[244:247], v[28:31]
    v_mul_f32 v48, v48, v206
    s_waitcnt vmcnt(4)
    v_mfma_f32_16x16x32_bf16 v[16:19], v[112:115], a[56:59], v[16:19]
    v_mfma_f32_16x16x32_bf16 v[20:23], v[112:115], a[120:123], v[20:23]
    v_mul_f32 v49, v49, v207
    v_mfma_f32_16x16x32_bf16 v[24:27], v[112:115], a[184:187], v[24:27]
    v_mul_f32 v50, v50, v208
    v_mfma_f32_16x16x32_bf16 v[28:31], v[112:115], a[248:251], v[28:31]
    v_mul_f32_e64 v51, v51, v209
    s_waitcnt vmcnt(3)
    v_mfma_f32_16x16x32_bf16 v[16:19], v[116:119], a[60:63], v[16:19]
    v_mfma_f32_16x16x32_bf16 v[20:23], v[116:119], a[124:127], v[20:23]
    v_cvt_pk_bf16_f32 v228, v48, v49
    v_mfma_f32_16x16x32_bf16 v[24:27], v[116:119], a[188:191], v[24:27]
    v_cvt_pk_bf16_f32 v229, v50, v51
    v_mfma_f32_16x16x32_bf16 v[28:31], v[116:119], a[252:255], v[28:31]
    v_lshlrev_b32 v206, 16, v186
    v_and_b32 v207, s74, v186
    v_lshlrev_b32 v208, 16, v187
    v_and_b32 v209, s74, v187
    ds_write_b128 v120, v[20:23] offset:0
    s_nop 0
    ds_write_b128 v121, v[24:27] offset:0
    s_nop 0
    ds_write_b128 v122, v[28:31] offset:0
    v_add_f32 v16, v16, v14
    v_add_f32 v17, v17, v14
    v_add_f32 v18, v18, v14
    v_add_f32 v19, v19, v14
    s_waitcnt lgkmcnt(0)
    s_barrier
    ds_read_b128 v[48:51], v123 offset:0
    ds_read_b128 v[52:55], v123 offset:1024
    ds_read_b128 v[56:59], v123 offset:2048
    s_waitcnt lgkmcnt(2)
    v_pk_add_f32 v[16:17], v[16:17], v[48:49]
    v_pk_add_f32 v[18:19], v[18:19], v[50:51]
    s_waitcnt lgkmcnt(1)
    v_pk_add_f32 v[16:17], v[16:17], v[52:53]
    v_pk_add_f32 v[18:19], v[18:19], v[54:55]
    s_waitcnt lgkmcnt(0)
    v_pk_add_f32 v[16:17], v[16:17], v[56:57]
    v_pk_add_f32 v[18:19], v[18:19], v[58:59]
    v_pk_mul_f32 v[48:49], v[16:17], v[206:207]
    v_pk_mul_f32 v[50:51], v[18:19], v[208:209]
    v_cvt_pk_bf16_f32 v230, v48, v49
    v_cvt_pk_bf16_f32 v231, v50, v51
    buffer_store_dwordx4 v[228:231], v1, s[48:51], s8 offen offset:2048 sc1
    s_cmp_ge_u32 s57, 14
    s_cbranch_scc1 L_helper_end
    v_lshrrev_b32 v8, 2, v0
    v_bfe_u32 v9, v8, 1, 2
    v_lshlrev_b32 v8, 7, v8
    v_lshl_add_u32 v8, v9, 5, v8
    v_and_b32 v9, 3, v0
    v_lshl_add_u32 v8, v9, 3, v8
    v_xor_b32 v9, 32, v8
    v_xor_b32 v10, 64, v8
    v_xor_b32 v11, 96, v8
    v_add_u32 v4, 92160, v8
    v_add_u32 v5, 92160, v9
    v_add_u32 v6, 92160, v10
    v_add_u32 v7, 92160, v11
    ds_read_b64_tr_b16 a[0:1], v4 offset:0
    s_add_u32 m0, s89, 0
    s_add_u32 s76, s88, 401408
    ds_read_b64_tr_b16 a[2:3], v4 offset:2048
    ds_read_b64_tr_b16 a[4:5], v5 offset:0
    ds_read_b64_tr_b16 a[6:7], v5 offset:2048
    ds_read_b64_tr_b16 a[8:9], v6 offset:0
    ds_read_b64_tr_b16 a[10:11], v6 offset:2048
    ds_read_b64_tr_b16 a[12:13], v7 offset:0
    buffer_load_dwordx4 v240, s[32:35], s76 offen lds
    ds_read_b64_tr_b16 a[14:15], v7 offset:2048
    ds_read_b64_tr_b16 a[16:17], v4 offset:4096
    ds_read_b64_tr_b16 a[18:19], v4 offset:6144
    ds_read_b64_tr_b16 a[20:21], v5 offset:4096
    ds_read_b64_tr_b16 a[22:23], v5 offset:6144
    ds_read_b64_tr_b16 a[24:25], v6 offset:4096
    buffer_load_dwordx4 v241, s[32:35], s76 offen offset:1024 lds
    ds_read_b64_tr_b16 a[26:27], v6 offset:6144
    ds_read_b64_tr_b16 a[28:29], v7 offset:4096
    ds_read_b64_tr_b16 a[30:31], v7 offset:6144
    ds_read_b64_tr_b16 a[32:33], v4 offset:8192
    ds_read_b64_tr_b16 a[34:35], v4 offset:10240
    ds_read_b64_tr_b16 a[36:37], v5 offset:8192
    buffer_load_dwordx4 v242, s[32:35], s76 offen offset:2048 lds
    ds_read_b64_tr_b16 a[38:39], v5 offset:10240
    ds_read_b64_tr_b16 a[40:41], v6 offset:8192
    ds_read_b64_tr_b16 a[42:43], v6 offset:10240
    ds_read_b64_tr_b16 a[44:45], v7 offset:8192
    ds_read_b64_tr_b16 a[46:47], v7 offset:10240
    ds_read_b64_tr_b16 a[48:49], v4 offset:12288
    buffer_load_dwordx4 v243, s[32:35], s76 offen offset:3072 lds
    ds_read_b64_tr_b16 a[50:51], v4 offset:14336
    ds_read_b64_tr_b16 a[52:53], v5 offset:12288
    ds_read_b64_tr_b16 a[54:55], v5 offset:14336
    ds_read_b64_tr_b16 a[56:57], v6 offset:12288
    ds_read_b64_tr_b16 a[58:59], v6 offset:14336
    ds_read_b64_tr_b16 a[60:61], v7 offset:12288
    ds_read_b64_tr_b16 a[62:63], v7 offset:14336
    s_add_u32 m0, s89, 4096
    s_add_u32 s76, s88, 430080
    ds_read_b64_tr_b16 a[64:65], v4 offset:16384
    ds_read_b64_tr_b16 a[66:67], v4 offset:18432
    ds_read_b64_tr_b16 a[68:69], v5 offset:16384
    ds_read_b64_tr_b16 a[70:71], v5 offset:18432
    ds_read_b64_tr_b16 a[72:73], v6 offset:16384
    ds_read_b64_tr_b16 a[74:75], v6 offset:18432
    buffer_load_dwordx4 v240, s[32:35], s76 offen lds
    ds_read_b64_tr_b16 a[76:77], v7 offset:16384
    ds_read_b64_tr_b16 a[78:79], v7 offset:18432
    ds_read_b64_tr_b16 a[80:81], v4 offset:20480
    ds_read_b64_tr_b16 a[82:83], v4 offset:22528
    ds_read_b64_tr_b16 a[84:85], v5 offset:20480
    ds_read_b64_tr_b16 a[86:87], v5 offset:22528
    buffer_load_dwordx4 v241, s[32:35], s76 offen offset:1024 lds
    ds_read_b64_tr_b16 a[88:89], v6 offset:20480
    ds_read_b64_tr_b16 a[90:91], v6 offset:22528
    ds_read_b64_tr_b16 a[92:93], v7 offset:20480
    ds_read_b64_tr_b16 a[94:95], v7 offset:22528
    ds_read_b64_tr_b16 a[96:97], v4 offset:24576
    ds_read_b64_tr_b16 a[98:99], v4 offset:26624
    buffer_load_dwordx4 v242, s[32:35], s76 offen offset:2048 lds
    ds_read_b64_tr_b16 a[100:101], v5 offset:24576
    ds_read_b64_tr_b16 a[102:103], v5 offset:26624
    ds_read_b64_tr_b16 a[104:105], v6 offset:24576
    ds_read_b64_tr_b16 a[106:107], v6 offset:26624
    ds_read_b64_tr_b16 a[108:109], v7 offset:24576
    ds_read_b64_tr_b16 a[110:111], v7 offset:26624
    s_waitcnt vmcnt(7)
    s_mov_b64 exec, 1
    buffer_atomic_add v3, off, s[48:51], s16 sc1
    s_mov_b64 exec, -1
    s_lshl2_add_u32 s80, s62, s52
    s_lshl_b32 s66, s80, 7
    s_add_u32 m0, s89, 28672
    s_add_u32 s76, s88, 602112
    s_add_u32 s66, s66, 811008
    s_mul_i32 s65, s80, 28672
    s_add_u32 s65, s65, 16777216
    ds_read_b64_tr_b16 a[112:113], v4 offset:28672
    ds_read_b64_tr_b16 a[114:115], v4 offset:30720
    buffer_load_dwordx4 v240, s[32:35], s76 offen lds
    ds_read_b64_tr_b16 a[116:117], v5 offset:28672
    ds_read_b64_tr_b16 a[118:119], v5 offset:30720
    ds_read_b64_tr_b16 a[120:121], v6 offset:28672
    ds_read_b64_tr_b16 a[122:123], v6 offset:30720
    buffer_load_dwordx4 v241, s[32:35], s76 offen offset:1024 lds
    ds_read_b64_tr_b16 a[124:125], v7 offset:28672
    ds_read_b64_tr_b16 a[126:127], v7 offset:30720
    ds_read_b64_tr_b16 a[128:129], v4 offset:32768
    ds_read_b64_tr_b16 a[130:131], v4 offset:34816
    ds_read_b64_tr_b16 a[132:133], v5 offset:32768
    buffer_load_dwordx4 v242, s[32:35], s76 offen offset:2048 lds
    ds_read_b64_tr_b16 a[134:135], v5 offset:34816
    ds_read_b64_tr_b16 a[136:137], v6 offset:32768
    ds_read_b64_tr_b16 a[138:139], v6 offset:34816
    ds_read_b64_tr_b16 a[140:141], v7 offset:32768
    buffer_load_dwordx4 v243, s[32:35], s76 offen offset:3072 lds
    ds_read_b64_tr_b16 a[142:143], v7 offset:34816
    ds_read_b64_tr_b16 a[144:145], v4 offset:36864
    ds_read_b64_tr_b16 a[146:147], v4 offset:38912
    ds_read_b64_tr_b16 a[148:149], v5 offset:36864
    ds_read_b64_tr_b16 a[150:151], v5 offset:38912
    s_add_u32 m0, s89, 32768
    s_add_u32 s76, s88, 630784
    ds_read_b64_tr_b16 a[152:153], v6 offset:36864
    ds_read_b64_tr_b16 a[154:155], v6 offset:38912
    ds_read_b64_tr_b16 a[156:157], v7 offset:36864
    ds_read_b64_tr_b16 a[158:159], v7 offset:38912
    buffer_load_dwordx4 v240, s[32:35], s76 offen lds
    ds_read_b64_tr_b16 a[160:161], v4 offset:40960
    ds_read_b64_tr_b16 a[162:163], v4 offset:43008
    ds_read_b64_tr_b16 a[164:165], v5 offset:40960
    ds_read_b64_tr_b16 a[166:167], v5 offset:43008
    ds_read_b64_tr_b16 a[168:169], v6 offset:40960
    buffer_load_dwordx4 v241, s[32:35], s76 offen offset:1024 lds
    ds_read_b64_tr_b16 a[170:171], v6 offset:43008
    ds_read_b64_tr_b16 a[172:173], v7 offset:40960
    ds_read_b64_tr_b16 a[174:175], v7 offset:43008
    ds_read_b64_tr_b16 a[176:177], v4 offset:45056
    buffer_load_dwordx4 v242, s[32:35], s76 offen offset:2048 lds
    ds_read_b64_tr_b16 a[178:179], v4 offset:47104
    ds_read_b64_tr_b16 a[180:181], v5 offset:45056
    ds_read_b64_tr_b16 a[182:183], v5 offset:47104
    ds_read_b64_tr_b16 a[184:185], v6 offset:45056
    ds_read_b64_tr_b16 a[186:187], v6 offset:47104
    ds_read_b64_tr_b16 a[188:189], v7 offset:45056
    ds_read_b64_tr_b16 a[190:191], v7 offset:47104
    ds_read_b64_tr_b16 a[192:193], v4 offset:49152
    ds_read_b64_tr_b16 a[194:195], v4 offset:51200
    ds_read_b64_tr_b16 a[196:197], v5 offset:49152
    ds_read_b64_tr_b16 a[198:199], v5 offset:51200
    ds_read_b64_tr_b16 a[200:201], v6 offset:49152
    ds_read_b64_tr_b16 a[202:203], v6 offset:51200
    ds_read_b64_tr_b16 a[204:205], v7 offset:49152
    ds_read_b64_tr_b16 a[206:207], v7 offset:51200
    ds_read_b64_tr_b16 a[208:209], v4 offset:53248
    ds_read_b64_tr_b16 a[210:211], v4 offset:55296
    ds_read_b64_tr_b16 a[212:213], v5 offset:53248
    ds_read_b64_tr_b16 a[214:215], v5 offset:55296
    ds_read_b64_tr_b16 a[216:217], v6 offset:53248
    ds_read_b64_tr_b16 a[218:219], v6 offset:55296
    ds_read_b64_tr_b16 a[220:221], v7 offset:53248
    ds_read_b64_tr_b16 a[222:223], v7 offset:55296
    ds_read_b128 v[192:195], v13 offset:256
    ds_read_b128 v[196:199], v13 offset:320
    ds_read_b128 v[200:203], v13 offset:384
    ds_read_b128 v[204:207], v13 offset:448
    v_permlane16_swap_b32 v248, v250
    v_permlane16_swap_b32 v249, v251
    v_permlane16_swap_b32 v252, v254
    v_permlane16_swap_b32 v253, v255
    v_lshlrev_b32 v224, 16, v248
    v_and_b32 v225, s74, v248
    v_lshlrev_b32 v226, 16, v249
    v_and_b32 v227, s74, v249
    v_lshlrev_b32 v228, 16, v250
    v_and_b32 v229, s74, v250
    v_lshlrev_b32 v230, 16, v251
    v_and_b32 v231, s74, v251
    v_lshlrev_b32 v232, 16, v252
    v_and_b32 v233, s74, v252
    v_lshlrev_b32 v234, 16, v253
    v_and_b32 v235, s74, v253
    v_lshlrev_b32 v236, 16, v254
    v_and_b32 v237, s74, v254
    v_lshlrev_b32 v238, 16, v255
    v_and_b32 v239, s74, v255
    s_mul_i32 s78, s53, 8
    s_mov_b64 exec, 1
    s_mov_b32 s72, 524288
L_poll4:
    v_mov_b32 v15, 0
    buffer_atomic_add v15, off, s[48:51], s66 sc0 sc1
    s_sub_u32 s72, s72, 1
    s_cbranch_scc1 L_pollx4
    s_waitcnt vmcnt(0)
    v_cmp_ne_u32 vcc, s78, v15
    s_nop 0
    s_cbranch_vccnz L_poll4
L_pollx4:
    s_mov_b64 exec, -1
    buffer_load_dwordx4 v[64:67], v1, s[48:51], s65 offen offset:0 sc1
    buffer_load_dwordx4 v[68:71], v1, s[48:51], s65 offen offset:1024 sc1
    buffer_load_dwordx4 v[72:75], v1, s[48:51], s65 offen offset:2048 sc1
    buffer_load_dwordx4 v[76:79], v1, s[48:51], s65 offen offset:3072 sc1
    s_add_u32 s65, s65, 4096
    buffer_load_dwordx4 v[80:83], v1, s[48:51], s65 offen offset:0 sc1
    buffer_load_dwordx4 v[84:87], v1, s[48:51], s65 offen offset:1024 sc1
    buffer_load_dwordx4 v[88:91], v1, s[48:51], s65 offen offset:2048 sc1
    buffer_load_dwordx4 v[92:95], v1, s[48:51], s65 offen offset:3072 sc1
    s_add_u32 s65, s65, 4096
    buffer_load_dwordx4 v[96:99], v1, s[48:51], s65 offen offset:0 sc1
    buffer_load_dwordx4 v[100:103], v1, s[48:51], s65 offen offset:1024 sc1
    buffer_load_dwordx4 v[104:107], v1, s[48:51], s65 offen offset:2048 sc1
    s_barrier
    ds_read_b64_tr_b16 a[224:225], v8 offset:0
    ds_read_b64_tr_b16 a[226:227], v8 offset:2048
    ds_read_b64_tr_b16 a[228:229], v9 offset:0
    ds_read_b64_tr_b16 a[230:231], v9 offset:2048
    ds_read_b64_tr_b16 a[232:233], v10 offset:0
    ds_read_b64_tr_b16 a[234:235], v10 offset:2048
    ds_read_b64_tr_b16 a[236:237], v11 offset:0
    ds_read_b64_tr_b16 a[238:239], v11 offset:2048
    ds_read_b64_tr_b16 a[240:241], v8 offset:4096
    ds_read_b64_tr_b16 a[242:243], v8 offset:6144
    ds_read_b64_tr_b16 a[244:245], v9 offset:4096
    ds_read_b64_tr_b16 a[246:247], v9 offset:6144
    ds_read_b64_tr_b16 a[248:249], v10 offset:4096
    ds_read_b64_tr_b16 a[250:251], v10 offset:6144
    ds_read_b64_tr_b16 a[252:253], v11 offset:4096
    ds_read_b64_tr_b16 a[254:255], v11 offset:6144
    s_waitcnt vmcnt(10) lgkmcnt(15)
    v_mfma_f32_16x16x32_bf16 v[176:179], a[0:3], v[64:67], 0
    buffer_load_dwordx4 v[108:111], v1, s[48:51], s65 offen offset:3072 sc1
    v_mfma_f32_16x16x32_bf16 v[180:183], a[4:7], v[64:67], 0
    ds_read_b64_tr_b16 a[0:1], v8 offset:8192
    v_mfma_f32_16x16x32_bf16 v[184:187], a[8:11], v[64:67], 0
    ds_read_b64_tr_b16 a[2:3], v8 offset:10240
    v_mfma_f32_16x16x32_bf16 v[188:191], a[12:15], v[64:67], 0
    ds_read_b64_tr_b16 a[4:5], v9 offset:8192
    s_waitcnt vmcnt(10)
    v_mfma_f32_16x16x32_bf16 v[176:179], a[16:19], v[68:71], v[176:179]
    s_add_u32 s65, s65, 4096
    buffer_load_dwordx4 v[112:115], v1, s[48:51], s65 offen offset:0 sc1
    ds_read_b64_tr_b16 a[6:7], v9 offset:10240
    v_mfma_f32_16x16x32_bf16 v[180:183], a[20:23], v[68:71], v[180:183]
    ds_read_b64_tr_b16 a[8:9], v10 offset:8192
    v_mfma_f32_16x16x32_bf16 v[184:187], a[24:27], v[68:71], v[184:187]
    ds_read_b64_tr_b16 a[10:11], v10 offset:10240
    v_mfma_f32_16x16x32_bf16 v[188:191], a[28:31], v[68:71], v[188:191]
    ds_read_b64_tr_b16 a[12:13], v11 offset:8192
    s_waitcnt vmcnt(10)
    v_mfma_f32_16x16x32_bf16 v[176:179], a[32:35], v[72:75], v[176:179]
    buffer_load_dwordx4 v[116:119], v1, s[48:51], s65 offen offset:1024 sc1
    ds_read_b64_tr_b16 a[14:15], v11 offset:10240
    v_mfma_f32_16x16x32_bf16 v[180:183], a[36:39], v[72:75], v[180:183]
    ds_read_b64_tr_b16 a[16:17], v8 offset:12288
    s_waitcnt vmcnt(10)
    v_permlane32_swap_b32 v76, v78
    v_permlane32_swap_b32 v77, v79
    v_mfma_f32_16x16x32_bf16 v[184:187], a[40:43], v[72:75], v[184:187]
    ds_read_b64_tr_b16 a[18:19], v8 offset:14336
    v_mfma_f32_16x16x32_bf16 v[188:191], a[44:47], v[72:75], v[188:191]
    ds_read_b64_tr_b16 a[20:21], v9 offset:12288
    v_mfma_f32_16x16x32_bf16 v[176:179], a[48:51], v[76:79], v[176:179]
    buffer_load_dwordx4 v[120:123], v1, s[48:51], s65 offen offset:2048 sc1
    ds_read_b64_tr_b16 a[22:23], v9 offset:14336
    v_mfma_f32_16x16x32_bf16 v[180:183], a[52:55], v[76:79], v[180:183]
    ds_read_b64_tr_b16 a[24:25], v10 offset:12288
    v_mfma_f32_16x16x32_bf16 v[184:187], a[56:59], v[76:79], v[184:187]
    ds_read_b64_tr_b16 a[26:27], v10 offset:14336
    v_mfma_f32_16x16x32_bf16 v[188:191], a[60:63], v[76:79], v[188:191]
    ds_read_b64_tr_b16 a[28:29], v11 offset:12288
    s_waitcnt vmcnt(10)
    v_mfma_f32_16x16x32_bf16 v[176:179], a[64:67], v[80:83], v[176:179]
    buffer_load_dwordx4 v[124:127], v1, s[48:51], s65 offen offset:3072 sc1
    ds_read_b64_tr_b16 a[30:31], v11 offset:14336
    v_mfma_f32_16x16x32_bf16 v[180:183], a[68:71], v[80:83], v[180:183]
    ds_read_b64_tr_b16 a[32:33], v8 offset:16384
    v_mfma_f32_16x16x32_bf16 v[184:187], a[72:75], v[80:83], v[184:187]
    ds_read_b64_tr_b16 a[34:35], v8 offset:18432
    v_mfma_f32_16x16x32_bf16 v[188:191], a[76:79], v[80:83], v[188:191]
    ds_read_b64_tr_b16 a[36:37], v9 offset:16384
    s_waitcnt vmcnt(10)
    v_mfma_f32_16x16x32_bf16 v[176:179], a[80:83], v[84:87], v[176:179]
    s_add_u32 s65, s65, 4096
    buffer_load_dwordx4 v[128:131], v1, s[48:51], s65 offen offset:0 sc1
    ds_read_b64_tr_b16 a[38:39], v9 offset:18432
    v_mfma_f32_16x16x32_bf16 v[180:183], a[84:87], v[84:87], v[180:183]
    ds_read_b64_tr_b16 a[40:41], v10 offset:16384
    v_mfma_f32_16x16x32_bf16 v[184:187], a[88:91], v[84:87], v[184:187]
    ds_read_b64_tr_b16 a[42:43], v10 offset:18432
    v_mfma_f32_16x16x32_bf16 v[188:191], a[92:95], v[84:87], v[188:191]
    ds_read_b64_tr_b16 a[44:45], v11 offset:16384
    s_waitcnt vmcnt(10)
    v_mfma_f32_16x16x32_bf16 v[176:179], a[96:99], v[88:91], v[176:179]
    buffer_load_dwordx4 v[132:135], v1, s[48:51], s65 offen offset:1024 sc1
    ds_read_b64_tr_b16 a[46:47], v11 offset:18432
    v_mfma_f32_16x16x32_bf16 v[180:183], a[100:103], v[88:91], v[180:183]
    ds_read_b64_tr_b16 a[48:49], v8 offset:20480
    v_mfma_f32_16x16x32_bf16 v[184:187], a[104:107], v[88:91], v[184:187]
    ds_read_b64_tr_b16 a[50:51], v8 offset:22528
    v_mfma_f32_16x16x32_bf16 v[188:191], a[108:111], v[88:91], v[188:191]
    ds_read_b64_tr_b16 a[52:53], v9 offset:20480
    s_waitcnt vmcnt(10)
    v_mfma_f32_16x16x32_bf16 v[176:179], a[112:115], v[92:95], v[176:179]
    buffer_load_dwordx4 v[136:139], v1, s[48:51], s65 offen offset:2048 sc1
    ds_read_b64_tr_b16 a[54:55], v9 offset:22528
    v_mfma_f32_16x16x32_bf16 v[180:183], a[116:119], v[92:95], v[180:183]
    ds_read_b64_tr_b16 a[56:57], v10 offset:20480
    v_mfma_f32_16x16x32_bf16 v[184:187], a[120:123], v[92:95], v[184:187]
    ds_read_b64_tr_b16 a[58:59], v10 offset:22528
    v_mfma_f32_16x16x32_bf16 v[188:191], a[124:127], v[92:95], v[188:191]
    ds_read_b64_tr_b16 a[60:61], v11 offset:20480
    s_waitcnt vmcnt(10)
    v_mfma_f32_16x16x32_bf16 v[176:179], a[128:131], v[96:99], v[176:179]
    buffer_load_dwordx4 v[140:143], v1, s[48:51], s65 offen offset:3072 sc1
    ds_read_b64_tr_b16 a[62:63], v11 offset:22528
    v_mfma_f32_16x16x32_bf16 v[180:183], a[132:135], v[96:99], v[180:183]
    ds_read_b64_tr_b16 a[64:65], v8 offset:24576
    v_mfma_f32_16x16x32_bf16 v[184:187], a[136:139], v[96:99], v[184:187]
    ds_read_b64_tr_b16 a[66:67], v8 offset:26624
    v_mfma_f32_16x16x32_bf16 v[188:191], a[140:143], v[96:99], v[188:191]
    ds_read_b64_tr_b16 a[68:69], v9 offset:24576
    s_waitcnt vmcnt(10)
    v_mfma_f32_16x16x32_bf16 v[176:179], a[144:147], v[100:103], v[176:179]
    s_add_u32 s65, s65, 4096
    buffer_load_dwordx4 v[144:147], v1, s[48:51], s65 offen offset:0 sc1
    ds_read_b64_tr_b16 a[70:71], v9 offset:26624
    v_mfma_f32_16x16x32_bf16 v[180:183], a[148:151], v[100:103], v[180:183]
    ds_read_b64_tr_b16 a[72:73], v10 offset:24576
    s_branch L_page8
.p2align 12
L_stub8:
    s_branch L_walked
L_page8:
    s_waitcnt vmcnt(10)
    v_permlane32_swap_b32 v104, v106
    v_permlane32_swap_b32 v105, v107
    v_mfma_f32_16x16x32_bf16 v[184:187], a[152:155], v[100:103], v[184:187]
    ds_read_b64_tr_b16 a[74:75], v10 offset:26624
    v_mfma_f32_16x16x32_bf16 v[188:191], a[156:159], v[100:103], v[188:191]
    ds_read_b64_tr_b16 a[76:77], v11 offset:24576
    v_mfma_f32_16x16x32_bf16 v[176:179], a[160:163], v[104:107], v[176:179]
    buffer_load_dwordx4 v[148:151], v1, s[48:51], s65 offen offset:1024 sc1
    ds_read_b64_tr_b16 a[78:79], v11 offset:26624
    v_mfma_f32_16x16x32_bf16 v[180:183], a[164:167], v[104:107], v[180:183]
    ds_read_b64_tr_b16 a[80:81], v8 offset:28672
    v_mfma_f32_16x16x32_bf16 v[184:187], a[168:171], v[104:107], v[184:187]
    ds_read_b64_tr_b16 a[82:83], v8 offset:30720
    v_mfma_f32_16x16x32_bf16 v[188:191], a[172:175], v[104:107], v[188:191]
    ds_read_b64_tr_b16 a[84:85], v9 offset:28672
    s_waitcnt vmcnt(10)
    v_mfma_f32_16x16x32_bf16 v[176:179], a[176:179], v[108:111], v[176:179]
    buffer_load_dwordx4 v[152:155], v1, s[48:51], s65 offen offset:2048 sc1
    ds_read_b64_tr_b16 a[86:87], v9 offset:30720
    v_mfma_f32_16x16x32_bf16 v[180:183], a[180:183], v[108:111], v[180:183]
    ds_read_b64_tr_b16 a[88:89], v10 offset:28672
    v_mfma_f32_16x16x32_bf16 v[184:187], a[184:187], v[108:111], v[184:187]
    ds_read_b64_tr_b16 a[90:91], v10 offset:30720
    v_mfma_f32_16x16x32_bf16 v[188:191], a[188:191], v[108:111], v[188:191]
    ds_read_b64_tr_b16 a[92:93], v11 offset:28672
    s_waitcnt vmcnt(10)
    v_mfma_f32_16x16x32_bf16 v[176:179], a[192:195], v[112:115], v[176:179]
    buffer_load_dwordx4 v[156:159], v1, s[48:51], s65 offen offset:3072 sc1
    ds_read_b64_tr_b16 a[94:95], v11 offset:30720
    v_mfma_f32_16x16x32_bf16 v[180:183], a[196:199], v[112:115], v[180:183]
    ds_read_b64_tr_b16 a[96:97], v8 offset:32768
    v_mfma_f32_16x16x32_bf16 v[184:187], a[200:203], v[112:115], v[184:187]
    ds_read_b64_tr_b16 a[98:99], v8 offset:34816
    v_mfma_f32_16x16x32_bf16 v[188:191], a[204:207], v[112:115], v[188:191]
    ds_read_b64_tr_b16 a[100:101], v9 offset:32768
    s_waitcnt vmcnt(10)
    v_mfma_f32_16x16x32_bf16 v[176:179], a[208:211], v[116:119], v[176:179]
    s_add_u32 s65, s65, 4096
    buffer_load_dwordx4 v[160:163], v1, s[48:51], s65 offen offset:0 sc1
    ds_read_b64_tr_b16 a[102:103], v9 offset:34816
    v_mfma_f32_16x16x32_bf16 v[180:183], a[212:215], v[116:119], v[180:183]
    ds_read_b64_tr_b16 a[104:105], v10 offset:32768
    v_mfma_f32_16x16x32_bf16 v[184:187], a[216:219], v[116:119], v[184:187]
    ds_read_b64_tr_b16 a[106:107], v10 offset:34816
    v_mfma_f32_16x16x32_bf16 v[188:191], a[220:223], v[116:119], v[188:191]
    ds_read_b64_tr_b16 a[108:109], v11 offset:32768
    s_waitcnt vmcnt(10) lgkmcnt(15)
    v_mfma_f32_16x16x32_bf16 v[176:179], a[224:227], v[120:123], v[176:179]
    buffer_load_dwordx4 v[164:167], v1, s[48:51], s65 offen offset:1024 sc1
    ds_read_b64_tr_b16 a[110:111], v11 offset:34816
    v_mfma_f32_16x16x32_bf16 v[180:183], a[228:231], v[120:123], v[180:183]
    ds_read_b64_tr_b16 a[112:113], v8 offset:36864
    v_mfma_f32_16x16x32_bf16 v[184:187], a[232:235], v[120:123], v[184:187]
    ds_read_b64_tr_b16 a[114:115], v8 offset:38912
    v_mfma_f32_16x16x32_bf16 v[188:191], a[236:239], v[120:123], v[188:191]
    ds_read_b64_tr_b16 a[116:117], v9 offset:36864
    s_waitcnt vmcnt(10)
    v_mfma_f32_16x16x32_bf16 v[176:179], a[240:243], v[124:127], v[176:179]
    buffer_load_dwordx4 v[168:171], v1, s[48:51], s65 offen offset:2048 sc1
    ds_read_b64_tr_b16 a[118:119], v9 offset:38912
    v_mfma_f32_16x16x32_bf16 v[180:183], a[244:247], v[124:127], v[180:183]
    ds_read_b64_tr_b16 a[120:121], v10 offset:36864
    v_mfma_f32_16x16x32_bf16 v[184:187], a[248:251], v[124:127], v[184:187]
    ds_read_b64_tr_b16 a[122:123], v10 offset:38912
    v_mfma_f32_16x16x32_bf16 v[188:191], a[252:255], v[124:127], v[188:191]
    ds_read_b64_tr_b16 a[124:125], v11 offset:36864
    s_waitcnt vmcnt(10)
    v_mfma_f32_16x16x32_bf16 v[176:179], a[0:3], v[128:131], v[176:179]
    buffer_load_dwordx4 v[172:175], v1, s[48:51], s65 offen offset:3072 sc1
    ds_read_b64_tr_b16 a[126:127], v11 offset:38912
    v_mfma_f32_16x16x32_bf16 v[180:183], a[4:7], v[128:131], v[180:183]
    ds_read_b64_tr_b16 a[128:129], v8 offset:40960
    s_waitcnt vmcnt(10)
    v_permlane32_swap_b32 v132, v134
    v_permlane32_swap_b32 v133, v135
    v_mfma_f32_16x16x32_bf16 v[184:187], a[8:11], v[128:131], v[184:187]
    ds_read_b64_tr_b16 a[130:131], v8 offset:43008
    v_mfma_f32_16x16x32_bf16 v[188:191], a[12:15], v[128:131], v[188:191]
    ds_read_b64_tr_b16 a[132:133], v9 offset:40960
    v_mfma_f32_16x16x32_bf16 v[176:179], a[16:19], v[132:135], v[176:179]
    ds_read_b64_tr_b16 a[134:135], v9 offset:43008
    v_mfma_f32_16x16x32_bf16 v[180:183], a[20:23], v[132:135], v[180:183]
    ds_read_b64_tr_b16 a[136:137], v10 offset:40960
    v_mfma_f32_16x16x32_bf16 v[184:187], a[24:27], v[132:135], v[184:187]
    ds_read_b64_tr_b16 a[138:139], v10 offset:43008
    v_mfma_f32_16x16x32_bf16 v[188:191], a[28:31], v[132:135], v[188:191]
    ds_read_b64_tr_b16 a[140:141], v11 offset:40960
    s_waitcnt vmcnt(9)
    v_mfma_f32_16x16x32_bf16 v[176:179], a[32:35], v[136:139], v[176:179]
    ds_read_b64_tr_b16 a[142:143], v11 offset:43008
    v_mfma_f32_16x16x32_bf16 v[180:183], a[36:39], v[136:139], v[180:183]
    ds_read_b64_tr_b16 a[144:145], v8 offset:45056
    v_mfma_f32_16x16x32_bf16 v[184:187], a[40:43], v[136:139], v[184:187]
    ds_read_b64_tr_b16 a[146:147], v8 offset:47104
    v_mfma_f32_16x16x32_bf16 v[188:191], a[44:47], v[136:139], v[188:191]
    ds_read_b64_tr_b16 a[148:149], v9 offset:45056
    s_waitcnt vmcnt(8)
    v_mfma_f32_16x16x32_bf16 v[176:179], a[48:51], v[140:143], v[176:179]
    ds_read_b64_tr_b16 a[150:151], v9 offset:47104
    v_mfma_f32_16x16x32_bf16 v[180:183], a[52:55], v[140:143], v[180:183]
    ds_read_b64_tr_b16 a[152:153], v10 offset:45056
    v_mfma_f32_16x16x32_bf16 v[184:187], a[56:59], v[140:143], v[184:187]
    ds_read_b64_tr_b16 a[154:155], v10 offset:47104
    v_mfma_f32_16x16x32_bf16 v[188:191], a[60:63], v[140:143], v[188:191]
    ds_read_b64_tr_b16 a[156:157], v11 offset:45056
    s_waitcnt vmcnt(7)
    v_mfma_f32_16x16x32_bf16 v[176:179], a[64:67], v[144:147], v[176:179]
    ds_read_b64_tr_b16 a[158:159], v11 offset:47104
    v_mfma_f32_16x16x32_bf16 v[180:183], a[68:71], v[144:147], v[180:183]
    ds_read_b64_tr_b16 a[160:161], v8 offset:49152
    v_mfma_f32_16x16x32_bf16 v[184:187], a[72:75], v[144:147], v[184:187]
    ds_read_b64_tr_b16 a[162:163], v8 offset:51200
    v_mfma_f32_16x16x32_bf16 v[188:191], a[76:79], v[144:147], v[188:191]
    ds_read_b64_tr_b16 a[164:165], v9 offset:49152
    s_waitcnt vmcnt(6) lgkmcnt(15)
    v_mfma_f32_16x16x32_bf16 v[176:179], a[80:83], v[148:151], v[176:179]
    ds_read_b64_tr_b16 a[166:167], v9 offset:51200
    v_mfma_f32_16x16x32_bf16 v[180:183], a[84:87], v[148:151], v[180:183]
    ds_read_b64_tr_b16 a[168:169], v10 offset:49152
    v_mfma_f32_16x16x32_bf16 v[184:187], a[88:91], v[148:151], v[184:187]
    ds_read_b64_tr_b16 a[170:171], v10 offset:51200
    v_mfma_f32_16x16x32_bf16 v[188:191], a[92:95], v[148:151], v[188:191]
    ds_read_b64_tr_b16 a[172:173], v11 offset:49152
    s_waitcnt vmcnt(5)
    v_mfma_f32_16x16x32_bf16 v[176:179], a[96:99], v[152:155], v[176:179]
    ds_read_b64_tr_b16 a[174:175], v11 offset:51200
    v_mfma_f32_16x16x32_bf16 v[180:183], a[100:103], v[152:155], v[180:183]
    ds_read_b64_tr_b16 a[176:177], v8 offset:53248
    v_mfma_f32_16x16x32_bf16 v[184:187], a[104:107], v[152:155], v[184:187]
    ds_read_b64_tr_b16 a[178:179], v8 offset:55296
    v_mfma_f32_16x16x32_bf16 v[188:191], a[108:111], v[152:155], v[188:191]
    ds_read_b64_tr_b16 a[180:181], v9 offset:53248
    s_waitcnt vmcnt(4)
    v_mfma_f32_16x16x32_bf16 v[176:179], a[112:115], v[156:159], v[176:179]
    ds_read_b64_tr_b16 a[182:183], v9 offset:55296
    v_mfma_f32_16x16x32_bf16 v[180:183], a[116:119], v[156:159], v[180:183]
    ds_read_b64_tr_b16 a[184:185], v10 offset:53248
    s_waitcnt vmcnt(3)
    v_permlane32_swap_b32 v160, v162
    v_permlane32_swap_b32 v161, v163
    v_mfma_f32_16x16x32_bf16 v[184:187], a[120:123], v[156:159], v[184:187]
    ds_read_b64_tr_b16 a[186:187], v10 offset:55296
    v_mfma_f32_16x16x32_bf16 v[188:191], a[124:127], v[156:159], v[188:191]
    ds_read_b64_tr_b16 a[188:189], v11 offset:53248
    s_waitcnt lgkmcnt(15)
    v_mfma_f32_16x16x32_bf16 v[176:179], a[128:131], v[160:163], v[176:179]
    ds_read_b64_tr_b16 a[190:191], v11 offset:55296
    v_mfma_f32_16x16x32_bf16 v[180:183], a[132:135], v[160:163], v[180:183]
    v_mfma_f32_16x16x32_bf16 v[184:187], a[136:139], v[160:163], v[184:187]
    v_mfma_f32_16x16x32_bf16 v[188:191], a[140:143], v[160:163], v[188:191]
    s_waitcnt vmcnt(2)
    v_mfma_f32_16x16x32_bf16 v[176:179], a[144:147], v[164:167], v[176:179]
    v_mfma_f32_16x16x32_bf16 v[180:183], a[148:151], v[164:167], v[180:183]
    v_mfma_f32_16x16x32_bf16 v[184:187], a[152:155], v[164:167], v[184:187]
    v_mfma_f32_16x16x32_bf16 v[188:191], a[156:159], v[164:167], v[188:191]
    s_waitcnt vmcnt(1) lgkmcnt(8)
    v_mfma_f32_16x16x32_bf16 v[176:179], a[160:163], v[168:171], v[176:179]
    v_mfma_f32_16x16x32_bf16 v[180:183], a[164:167], v[168:171], v[180:183]
    v_mfma_f32_16x16x32_bf16 v[184:187], a[168:171], v[168:171], v[184:187]
    v_mfma_f32_16x16x32_bf16 v[188:191], a[172:175], v[168:171], v[188:191]
    s_waitcnt vmcnt(0) lgkmcnt(0)
    v_mfma_f32_16x16x32_bf16 v[176:179], a[176:179], v[172:175], v[176:179]
    v_mfma_f32_16x16x32_bf16 v[180:183], a[180:183], v[172:175], v[180:183]
    v_mfma_f32_16x16x32_bf16 v[184:187], a[184:187], v[172:175], v[184:187]
    v_mfma_f32_16x16x32_bf16 v[188:191], a[188:191], v[172:175], v[188:191]
    s_nop 4
    v_pk_fma_f32 v[224:225], v[176:177], v[192:193], v[224:225]
    v_cvt_pk_bf16_f32 v16, v224, v225
    v_pk_fma_f32 v[226:227], v[178:179], v[194:195], v[226:227]
    v_cvt_pk_bf16_f32 v17, v226, v227
    v_pk_fma_f32 v[228:229], v[180:181], v[196:197], v[228:229]
    v_cvt_pk_bf16_f32 v18, v228, v229
    v_pk_fma_f32 v[230:231], v[182:183], v[198:199], v[230:231]
    v_cvt_pk_bf16_f32 v19, v230, v231
    v_permlane16_swap_b32 v16, v18
    s_nop 0
    v_permlane16_swap_b32 v17, v19
    buffer_store_dwordx4 v[16:19], v12, s[44:47], s82 offen offset:0
    v_pk_fma_f32 v[232:233], v[184:185], v[200:201], v[232:233]
    v_cvt_pk_bf16_f32 v20, v232, v233
    v_pk_fma_f32 v[234:235], v[186:187], v[202:203], v[234:235]
    v_cvt_pk_bf16_f32 v21, v234, v235
    v_pk_fma_f32 v[236:237], v[188:189], v[204:205], v[236:237]
    v_cvt_pk_bf16_f32 v22, v236, v237
    v_pk_fma_f32 v[238:239], v[190:191], v[206:207], v[238:239]
    v_cvt_pk_bf16_f32 v23, v238, v239
    v_permlane16_swap_b32 v20, v22
    s_nop 0
    v_permlane16_swap_b32 v21, v23
    buffer_store_dwordx4 v[20:23], v12, s[44:47], s82 offen offset:64
    s_endpgm
L_helper_end:
    s_waitcnt vmcnt(0)
    s_mov_b64 exec, 1
    buffer_atomic_add v3, off, s[48:51], s16 sc1
    s_mov_b64 exec, -1
    s_lshl_b32 s64, s61, 3
    s_add_u32 s64, s64, s60
    s_cmp_lg_u32 s64, 255
    s_cbranch_scc1 L_noepoch
    s_mov_b64 exec, 1
    buffer_store_dword v3, off, s[48:51], 0 sc1
    s_mov_b64 exec, -1
L_noepoch:
    s_endpgm
L_gateretry:
    s_mov_b32 s72, 524288
L_poll5:
    buffer_load_dwordx4 v[180:183], v23, s[48:51], s67 offen sc1
    buffer_load_dwordx4 v[184:187], v23, s[48:51], s68 offen sc1
    s_sub_u32 s72, s72, 1
    s_cbranch_scc1 L_pollx5
    s_waitcnt vmcnt(0)
    v_xor_b32 v180, s12, v180
    v_xor_b32 v181, s13, v181
    v_xor_b32 v182, s14, v182
    v_xor_b32 v183, s15, v183
    v_xor_b32 v184, s12, v184
    v_xor_b32 v185, s13, v185
    v_xor_b32 v186, s14, v186
    v_xor_b32 v187, s15, v187
    v_or3_b32 v18, v180, v181, v182
    v_or3_b32 v18, v18, v183, v184
    v_or3_b32 v18, v18, v185, v186
    v_or_b32 v18, v18, v187
    v_and_b32 v18, 0xff, v18
    v_cmp_ne_u32 vcc, 0, v18
    s_nop 0
    s_cbranch_vccnz L_poll5
L_pollx5:
    s_branch L_gateok
L_lnretry:
    s_mov_b32 s72, 524288
L_poll6:
    buffer_load_dwordx4 v[16:19], v235, s[48:51], s70 offen sc1
    s_sub_u32 s72, s72, 1
    s_cbranch_scc1 L_pollx6
    s_waitcnt vmcnt(0)
    v_xor_b32 v19, s53, v19
    v_cmp_ne_u32 vcc, 0, v19
    s_nop 0
    s_cbranch_vccnz L_poll6
L_pollx6:
    s_branch L_lnok
L_kvretry:
    s_mov_b32 s72, 524288
L_poll7:
    buffer_load_dwordx4 v[116:119], v1, s[48:51], s65 offen sc1
    s_add_u32 s66, s65, 4096
    buffer_load_dwordx4 v[120:123], v1, s[48:51], s66 offen sc1
    s_add_u32 s66, s65, 8192
    buffer_load_dwordx4 v[124:127], v1, s[48:51], s66 offen sc1
    s_add_u32 s66, s65, 12288
    buffer_load_dwordx4 v[128:131], v1, s[48:51], s66 offen sc1
    s_add_u32 s66, s65, 16384
    buffer_load_dwordx4 v[132:135], v1, s[48:51], s66 offen sc1
    s_add_u32 s66, s65, 20480
    buffer_load_dwordx4 v[136:139], v1, s[48:51], s66 offen sc1
    s_add_u32 s66, s65, 24576
    buffer_load_dwordx4 v[140:143], v1, s[48:51], s66 offen sc1
    s_add_u32 s66, s65, 28672
    buffer_load_dwordx4 v[144:147], v1, s[48:51], s66 offen sc1
    s_add_u32 s66, s65, 32768
    buffer_load_dwordx4 v[148:151], v1, s[48:51], s66 offen sc1
    s_add_u32 s66, s65, 36864
    buffer_load_dwordx4 v[152:155], v1, s[48:51], s66 offen sc1
    s_add_u32 s66, s65, 40960
    buffer_load_dwordx4 v[156:159], v1, s[48:51], s66 offen sc1
    s_add_u32 s66, s65, 45056
    buffer_load_dwordx4 v[160:163], v1, s[48:51], s66 offen sc1
    s_add_u32 s66, s65, 49152
    buffer_load_dwordx4 v[164:167], v1, s[48:51], s66 offen sc1
    s_add_u32 s66, s65, 53248
    buffer_load_dwordx4 v[168:171], v1, s[48:51], s66 offen sc1
    s_add_u32 s66, s65, 57344
    buffer_load_dwordx4 v[188:191], v1, s[48:51], s66 offen sc1
    s_add_u32 s66, s65, 61440
    buffer_load_dwordx4 v[192:195], v1, s[48:51], s66 offen sc1
    s_sub_u32 s72, s72, 1
    s_cbranch_scc1 L_pollx7
    s_waitcnt vmcnt(0)
    v_xor_b32_e64 v5, s3, v119
    v_bitop3_b32 v5, v5, v123, s3 bitop3:0xf6
    v_bitop3_b32 v5, v5, v127, s3 bitop3:0xf6
    v_bitop3_b32 v5, v5, v131, s3 bitop3:0xf6
    v_bitop3_b32 v5, v5, v135, s3 bitop3:0xf6
    v_bitop3_b32 v5, v5, v139, s3 bitop3:0xf6
    v_bitop3_b32 v5, v5, v143, s3 bitop3:0xf6
    v_bitop3_b32 v5, v5, v147, s3 bitop3:0xf6
    v_bitop3_b32 v5, v5, v151, s3 bitop3:0xf6
    v_bitop3_b32 v5, v5, v155, s3 bitop3:0xf6
    v_bitop3_b32 v5, v5, v159, s3 bitop3:0xf6
    v_bitop3_b32 v5, v5, v163, s3 bitop3:0xf6
    v_bitop3_b32 v5, v5, v167, s3 bitop3:0xf6
    v_bitop3_b32 v5, v5, v171, s3 bitop3:0xf6
    v_bitop3_b32 v5, v5, v191, s3 bitop3:0xf6
    v_bitop3_b32 v5, v5, v195, s3 bitop3:0xf6
    v_cmp_le_u32 vcc, 0x10000, v5
    s_nop 0
    s_cbranch_vccnz L_poll7
L_pollx7:
    s_cmp_eq_u32 s72, -1
    s_cbranch_scc1 L_kvok
    s_branch L_kvsum
L_s5retry:
    s_mov_b32 s72, 524288
L_poll8:
    buffer_load_dwordx4 v[24:27], v19, s[48:51], s83 offen sc1
    buffer_load_dwordx4 v[28:31], v19, s[48:51], s65 offen sc1
    buffer_load_dwordx4 v[32:35], v19, s[48:51], s66 offen sc1
    buffer_load_dwordx4 v[36:39], v19, s[48:51], s67 offen sc1
    buffer_load_dwordx4 v[40:43], v19, s[48:51], s68 offen sc1
    buffer_load_dwordx4 v[44:47], v19, s[48:51], s69 offen sc1
    buffer_load_dwordx4 v[48:51], v19, s[48:51], s70 offen sc1
    s_sub_u32 s72, s72, 1
    s_cbranch_scc1 L_pollx8
    s_waitcnt vmcnt(0)
    v_xor_b32_e64 v26, s53, v26
    v_bitop3_b32 v26, v26, v30, s53 bitop3:0xf6
    v_bitop3_b32 v26, v26, v34, s53 bitop3:0xf6
    v_bitop3_b32 v26, v26, v38, s53 bitop3:0xf6
    v_bitop3_b32 v26, v26, v42, s53 bitop3:0xf6
    v_bitop3_b32 v26, v26, v46, s53 bitop3:0xf6
    v_bitop3_b32 v26, v26, v50, s53 bitop3:0xf6
    v_cmp_ne_u32 vcc, 0, v26
    s_nop 0
    s_cbranch_vccnz L_poll8
L_pollx8:
    s_branch L_s5ok
L_s1b_wait:
    s_mul_i32 s78, s53, 12
    s_mov_b64 exec, 1
    s_mov_b32 s72, 524288
L_poll9:
    v_mov_b32 v232, 0
    buffer_atomic_add v232, off, s[48:51], s71 sc0 sc1
    s_sub_u32 s72, s72, 1
    s_cbranch_scc1 L_pollx9
    s_waitcnt vmcnt(0)
    v_cmp_ne_u32 vcc, s78, v232
    s_nop 0
    s_cbranch_vccnz L_poll9
L_pollx9:
    s_mov_b64 exec, -1
    s_branch L_s1b_ok
L_g8_wait:
    s_mul_i32 s78, s53, 14
    s_mov_b64 exec, 1
    s_mov_b32 s72, 524288
L_poll10:
    v_mov_b32 v7, 0
    buffer_atomic_add v7, off, s[48:51], s11 sc0 sc1
    s_sub_u32 s72, s72, 1
    s_cbranch_scc1 L_pollx10
    s_waitcnt vmcnt(0)
    v_cmp_ne_u32 vcc, s78, v7
    s_nop 0
    s_cbranch_vccnz L_poll10
L_pollx10:
    s_mov_b64 exec, -1
    s_branch L_g8_ok
L_skipunit1:
    v_lshrrev_b32 v4, 3, v0
    v_min_u32 v4, 6, v4
    v_mul_u32_u24 v4, 3584, v4
    v_and_b32 v5, 7, v0
    v_min_u32 v5, 6, v5
    v_lshl_add_u32 v4, v5, 7, v4
    s_and_b32 s64, s61, 28
    s_add_u32 s64, s64, s52
    s_and_b32 s65, s60, 1
    s_lshl_b32 s65, s65, 5
    s_add_u32 s64, s64, s65
    s_mul_i32 s64, s64, 25088
    s_lshr_b32 s65, s60, 1
    s_mul_i32 s65, s65, 896
    s_add_u32 s64, s64, s65
    buffer_load_dword v243, v4, s[20:23], s64 offen
    s_waitcnt vmcnt(1) lgkmcnt(0)
    s_branch L_nounit1
L_mod2retry:
    s_mov_b32 s72, 524288
L_poll11:
    buffer_load_dwordx4 v[140:143], v234, s[48:51], s66 offen sc1
    buffer_load_dwordx4 v[144:147], v234, s[48:51], s67 offen sc1
    buffer_load_dwordx4 v[148:151], v234, s[48:51], s68 offen sc1
    buffer_load_dwordx4 v[152:155], v234, s[48:51], s69 offen sc1
    s_sub_u32 s72, s72, 1
    s_cbranch_scc1 L_pollx11
    s_waitcnt vmcnt(0)
    v_xor_b32 v140, s12, v140
    v_xor_b32 v141, s13, v141
    v_xor_b32 v142, s14, v142
    v_xor_b32 v143, s15, v143
    v_xor_b32 v144, s12, v144
    v_xor_b32 v145, s13, v145
    v_xor_b32 v146, s14, v146
    v_xor_b32 v147, s15, v147
    v_xor_b32 v148, s12, v148
    v_xor_b32 v149, s13, v149
    v_xor_b32 v150, s14, v150
    v_xor_b32 v151, s15, v151
    v_xor_b32 v152, s12, v152
    v_xor_b32 v153, s13, v153
    v_xor_b32 v154, s14, v154
    v_xor_b32 v155, s15, v155
    v_or3_b32 v15, v140, v141, v142
    v_or3_b32 v15, v15, v143, v144
    v_or3_b32 v15, v15, v145, v146
    v_or3_b32 v15, v15, v147, v148
    v_or3_b32 v15, v15, v149, v150
    v_or3_b32 v15, v15, v151, v152
    v_or3_b32 v15, v15, v153, v154
    v_or_b32 v15, v15, v155
    v_and_b32 v15, 0xff, v15
    v_cmp_ne_u32 vcc, 0, v15
    s_nop 0
    s_cbranch_vccnz L_poll11
L_pollx11:
    s_branch L_mod2ok
L_helper:
    s_waitcnt vmcnt(0)
    s_mov_b64 exec, 1
    buffer_atomic_add v3, off, s[48:51], s75 sc1
    s_mov_b64 exec, -1
    s_lshr_b32 s64, s61, 4
    s_lshl1_add_u32 s64, s64, s57
    s_sub_u32 s64, s64, 14
    s_lshl_b32 s64, s64, 3
    s_add_u32 s87, s64, s60
    s_lshr_b32 s71, s87, 3
    s_and_b32 s65, s60, 1
    s_lshl2_add_u32 s64, s65, s71
    s_and_b32 s65, s58, 24
    s_add_u32 s65, s64, s65
    s_lshl_b32 s65, s65, 18
    s_lshl_b32 s66, s52, 10
    s_add_u32 s65, s65, s66
    v_lshrrev_b32 v4, 3, v0
    v_lshlrev_b32 v4, 12, v4
    v_and_b32 v5, 7, v0
    v_lshl_add_u32 v4, v5, 7, v4
    v_lshlrev_b32 v5, 7, v0
    s_lshl2_add_u32 s71, s71, s52
    s_mul_i32 s64, s71, 53760
    s_add_u32 s64, s64, 6291456
    s_mul_i32 s68, s71, 50176
    s_add_u32 s66, s52, 2
    s_and_b32 s66, s66, 3
    s_lshl_b32 s66, s66, 16
    s_add_u32 s66, s66, s65
    s_add_u32 s67, s66, 0
    buffer_load_dword v68, v4, s[24:27], s67 offen
    s_add_u32 s67, s66, 32768
    buffer_load_dword v69, v4, s[24:27], s67 offen
    s_waitcnt vmcnt(0)
    s_add_u32 s66, s52, 3
    s_and_b32 s66, s66, 3
    s_lshl_b32 s66, s66, 16
    s_add_u32 s66, s66, s65
    s_add_u32 s67, s66, 0
    buffer_load_dword v70, v4, s[24:27], s67 offen
    s_add_u32 s67, s66, 32768
    buffer_load_dword v71, v4, s[24:27], s67 offen
    s_waitcnt vmcnt(0)
    s_add_u32 s77, s52, 0
    s_and_b32 s77, s77, 3
    s_lshl_b32 s77, s77, 16
    s_add_u32 s77, s77, s86
    s_add_u32 s79, s59, 0
    s_and_b32 s79, s79, 3
    s_mul_i32 s76, s79, 4224
    s_add_u32 m0, s73, s76
    s_lshl_b32 s79, s79, 14
    s_add_u32 s76, s77, s79
    buffer_load_dwordx4 v228, s[24:27], s76 offen lds
    buffer_load_dwordx4 v229, s[24:27], s76 offen offset:1056 lds
    buffer_load_dwordx4 v230, s[24:27], s76 offen offset:2112 lds
    buffer_load_dwordx4 v231, s[24:27], s76 offen offset:3168 lds
    s_add_u32 s79, s59, 1
    s_and_b32 s79, s79, 3
    s_mul_i32 s76, s79, 4224
    s_add_u32 m0, s73, s76
    s_lshl_b32 s79, s79, 14
    s_add_u32 s76, s77, s79
    buffer_load_dwordx4 v228, s[24:27], s76 offen lds
    buffer_load_dwordx4 v229, s[24:27], s76 offen offset:1056 lds
    buffer_load_dwordx4 v230, s[24:27], s76 offen offset:2112 lds
    buffer_load_dwordx4 v231, s[24:27], s76 offen offset:3168 lds
    s_add_u32 s79, s59, 2
    s_and_b32 s79, s79, 3
    s_mul_i32 s76, s79, 4224
    s_add_u32 m0, s73, s76
    s_lshl_b32 s79, s79, 14
    s_add_u32 s76, s77, s79
    buffer_load_dwordx4 v228, s[24:27], s76 offen lds
    buffer_load_dwordx4 v229, s[24:27], s76 offen offset:1056 lds
    buffer_load_dwordx4 v230, s[24:27], s76 offen offset:2112 lds
    buffer_load_dwordx4 v231, s[24:27], s76 offen offset:3168 lds
    s_add_u32 s79, s59, 3
    s_and_b32 s79, s79, 3
    s_mul_i32 s76, s79, 4224
    s_add_u32 m0, s73, s76
    s_lshl_b32 s79, s79, 14
    s_add_u32 s76, s77, s79
    buffer_load_dwordx4 v228, s[24:27], s76 offen lds
    buffer_load_dwordx4 v229, s[24:27], s76 offen offset:1056 lds
    buffer_load_dwordx4 v230, s[24:27], s76 offen offset:2112 lds
    buffer_load_dwordx4 v231, s[24:27], s76 offen offset:3168 lds
    s_waitcnt vmcnt(0)
    v_and_b32 v8, 15, v0
    v_mul_u32_u24 v8, 1056, v8
    v_and_b32_e64 v9, 48, v0
    v_add3_u32 v8, v8, v9, s73
    ds_read_b128 a[0:3], v8 offset:0
    ds_read_b128 a[4:7], v8 offset:64
    ds_read_b128 a[8:11], v8 offset:128
    ds_read_b128 a[12:15], v8 offset:192
    ds_read_b128 a[16:19], v8 offset:256
    ds_read_b128 a[20:23], v8 offset:320
    ds_read_b128 a[24:27], v8 offset:384
    ds_read_b128 a[28:31], v8 offset:448
    ds_read_b128 a[32:35], v8 offset:512
    ds_read_b128 a[36:39], v8 offset:576
    ds_read_b128 a[40:43], v8 offset:640
    ds_read_b128 a[44:47], v8 offset:704
    ds_read_b128 a[48:51], v8 offset:768
    ds_read_b128 a[52:55], v8 offset:832
    ds_read_b128 a[56:59], v8 offset:896
    ds_read_b128 a[60:63], v8 offset:960
    s_waitcnt lgkmcnt(0)
    s_add_u32 s77, s52, 2
    s_and_b32 s77, s77, 3
    s_lshl_b32 s77, s77, 16
    s_add_u32 s77, s77, s86
    s_add_u32 s79, s59, 0
    s_and_b32 s79, s79, 3
    s_mul_i32 s76, s79, 4224
    s_add_u32 m0, s73, s76
    s_lshl_b32 s79, s79, 14
    s_add_u32 s76, s77, s79
    buffer_load_dwordx4 v228, s[24:27], s76 offen lds
    buffer_load_dwordx4 v229, s[24:27], s76 offen offset:1056 lds
    buffer_load_dwordx4 v230, s[24:27], s76 offen offset:2112 lds
    buffer_load_dwordx4 v231, s[24:27], s76 offen offset:3168 lds
    s_add_u32 s79, s59, 1
    s_and_b32 s79, s79, 3
    s_mul_i32 s76, s79, 4224
    s_add_u32 m0, s73, s76
    s_lshl_b32 s79, s79, 14
    s_add_u32 s76, s77, s79
    buffer_load_dwordx4 v228, s[24:27], s76 offen lds
    buffer_load_dwordx4 v229, s[24:27], s76 offen offset:1056 lds
    buffer_load_dwordx4 v230, s[24:27], s76 offen offset:2112 lds
    buffer_load_dwordx4 v231, s[24:27], s76 offen offset:3168 lds
    s_add_u32 s79, s59, 2
    s_and_b32 s79, s79, 3
    s_mul_i32 s76, s79, 4224
    s_add_u32 m0, s73, s76
    s_lshl_b32 s79, s79, 14
    s_add_u32 s76, s77, s79
    buffer_load_dwordx4 v228, s[24:27], s76 offen lds
    buffer_load_dwordx4 v229, s[24:27], s76 offen offset:1056 lds
    buffer_load_dwordx4 v230, s[24:27], s76 offen offset:2112 lds
    buffer_load_dwordx4 v231, s[24:27], s76 offen offset:3168 lds
    s_add_u32 s79, s59, 3
    s_and_b32 s79, s79, 3
    s_mul_i32 s76, s79, 4224
    s_add_u32 m0, s73, s76
    s_lshl_b32 s79, s79, 14
    s_add_u32 s76, s77, s79
    buffer_load_dwordx4 v228, s[24:27], s76 offen lds
    buffer_load_dwordx4 v229, s[24:27], s76 offen offset:1056 lds
    buffer_load_dwordx4 v230, s[24:27], s76 offen offset:2112 lds
    buffer_load_dwordx4 v231, s[24:27], s76 offen offset:3168 lds
    s_waitcnt vmcnt(0)
    v_and_b32 v8, 15, v0
    v_mul_u32_u24 v8, 1056, v8
    v_and_b32 v9, 48, v0
    v_add3_u32 v8, v8, v9, s73
    ds_read_b128 a[128:131], v8 offset:0
    ds_read_b128 a[132:135], v8 offset:64
    ds_read_b128 a[136:139], v8 offset:128
    ds_read_b128 a[140:143], v8 offset:192
    ds_read_b128 a[144:147], v8 offset:256
    ds_read_b128 a[148:151], v8 offset:320
    ds_read_b128 a[152:155], v8 offset:384
    ds_read_b128 a[156:159], v8 offset:448
    ds_read_b128 a[160:163], v8 offset:512
    ds_read_b128 a[164:167], v8 offset:576
    ds_read_b128 a[168:171], v8 offset:640
    ds_read_b128 a[172:175], v8 offset:704
    ds_read_b128 a[176:179], v8 offset:768
    ds_read_b128 a[180:183], v8 offset:832
    ds_read_b128 a[184:187], v8 offset:896
    ds_read_b128 a[188:191], v8 offset:960
    s_waitcnt lgkmcnt(0)
    s_add_u32 s77, s52, 3
    s_and_b32 s77, s77, 3
    s_lshl_b32 s77, s77, 16
    s_add_u32 s77, s77, s86
    s_add_u32 m0, s73, 0
    s_add_u32 s76, s77, 0
    buffer_load_dwordx4 v228, s[24:27], s76 offen lds
    buffer_load_dwordx4 v229, s[24:27], s76 offen offset:1056 lds
    buffer_load_dwordx4 v230, s[24:27], s76 offen offset:2112 lds
    buffer_load_dwordx4 v231, s[24:27], s76 offen offset:3168 lds
    s_add_u32 m0, s73, 4224
    s_add_u32 s76, s77, 16384
    buffer_load_dwordx4 v228, s[24:27], s76 offen lds
    buffer_load_dwordx4 v229, s[24:27], s76 offen offset:1056 lds
    buffer_load_dwordx4 v230, s[24:27], s76 offen offset:2112 lds
    buffer_load_dwordx4 v231, s[24:27], s76 offen offset:3168 lds
    s_add_u32 m0, s73, 8448
    s_add_u32 s76, s77, 32768
    buffer_load_dwordx4 v228, s[24:27], s76 offen lds
    buffer_load_dwordx4 v229, s[24:27], s76 offen offset:1056 lds
    buffer_load_dwordx4 v230, s[24:27], s76 offen offset:2112 lds
    buffer_load_dwordx4 v231, s[24:27], s76 offen offset:3168 lds
    s_add_u32 m0, s73, 12672
    s_add_u32 s76, s77, 49152
    buffer_load_dwordx4 v228, s[24:27], s76 offen lds
    buffer_load_dwordx4 v229, s[24:27], s76 offen offset:1056 lds
    buffer_load_dwordx4 v230, s[24:27], s76 offen offset:2112 lds
    buffer_load_dwordx4 v231, s[24:27], s76 offen offset:3168 lds
    s_waitcnt vmcnt(0)
    v_and_b32 v8, 15, v0
    v_mul_u32_u24 v8, 1056, v8
    v_and_b32 v9, 48, v0
    v_add3_u32 v8, v8, v9, s73
    ds_read_b128 a[192:195], v8 offset:0
    ds_read_b128 a[196:199], v8 offset:64
    ds_read_b128 a[200:203], v8 offset:128
    ds_read_b128 a[204:207], v8 offset:192
    ds_read_b128 a[208:211], v8 offset:256
    ds_read_b128 a[212:215], v8 offset:320
    ds_read_b128 a[216:219], v8 offset:384
    ds_read_b128 a[220:223], v8 offset:448
    ds_read_b128 a[224:227], v8 offset:512
    ds_read_b128 a[228:231], v8 offset:576
    ds_read_b128 a[232:235], v8 offset:640
    ds_read_b128 a[236:239], v8 offset:704
    ds_read_b128 a[240:243], v8 offset:768
    ds_read_b128 a[244:247], v8 offset:832
    ds_read_b128 a[248:251], v8 offset:896
    ds_read_b128 a[252:255], v8 offset:960
    s_add_u32 s67, s68, 0
    buffer_load_dword v64, v5, s[32:35], s67 offen
    s_add_u32 s67, s68, 8192
    buffer_load_dword v65, v5, s[32:35], s67 offen
    s_add_u32 s67, s68, 16384
    buffer_load_dword v66, v5, s[32:35], s67 offen
    s_add_u32 s67, s68, 24576
    buffer_load_dword v67, v5, s[32:35], s67 offen
    s_add_u32 s67, s68, 32768
    buffer_load_dword v68, v5, s[32:35], s67 offen
    s_add_u32 s67, s68, 40960
    buffer_load_dword v69, v5, s[32:35], s67 offen
    s_add_u32 s67, s68, 49152
    buffer_load_dword v70, v5, s[32:35], s67 offen
    s_waitcnt vmcnt(0)
    s_mul_i32 s18, s59, 112
    s_add_u32 s19, s18, 111
    s_lshr_b32 s18, s18, 6
    s_lshr_b32 s19, s19, 6
    s_sub_u32 s22, s19, s18
    s_lshl2_add_u32 s22, s22, 4
    s_mul_i32 s22, s22, s53
    s_and_b32 s20, s58, 3
    s_lshl2_add_u32 s10, s59, s52
    s_lshl2_add_u32 s10, s10, s20
    s_lshl_b32 s10, s10, 7
    s_add_u32 s10, s10, 827392
    v_and_b32 v15, 15, v0
    s_lshl2_add_u32 s4, s58, s52
    v_lshlrev_b32 v15, 1, v15
    s_lshl_b32 s17, s4, 5
    s_and_b32 s5, s59, 1
    s_mul_i32 s18, s59, 7
    s_add_u32 s19, s18, s5
    s_xor_b32 s20, s5, 1
    s_mul_i32 s20, s20, 6
    s_add_u32 s18, s18, s20
    s_mul_i32 s20, s52, 16384
    s_add_u32 s20, s20, 8388608
    s_mul_i32 s6, s19, 65536
    s_add_u32 s6, s6, s20
    s_mul_i32 s7, s18, 65536
    s_add_u32 s7, s7, s20
    s_mul_i32 s20, s4, 28672
    s_lshr_b32 s19, s19, 1
    s_lshl_b32 s19, s19, 10
    s_add_u32 s8, s19, s20
    s_lshr_b32 s18, s18, 1
    s_lshl_b32 s18, s18, 10
    s_add_u32 s9, s18, s20
    s_lshl_b32 s18, s5, 3
    s_add_u32 s9, s9, s18
    s_lshl_b32 s16, s4, 7
    s_add_u32 s16, s16, 811008
    s_lshr_b32 s11, s4, 1
    s_lshl_b32 s11, s11, 7
    s_add_u32 s11, s11, 872448
    s_mul_i32 s36, s52, 3072
    s_add_u32 s36, s36, 67584
    s_add_u32 s37, s52, 1
    s_and_b32 s37, s37, 3
    s_mul_i32 s37, s37, 3072
    s_add_u32 s37, s37, 67584
    s_add_u32 s38, s52, 2
    s_and_b32 s38, s38, 3
    s_mul_i32 s38, s38, 3072
    s_add_u32 s38, s38, 68608
    s_add_u32 s39, s52, 3
    s_and_b32 s39, s39, 3
    s_mul_i32 s39, s39, 3072
    s_add_u32 s39, s39, 69632
    buffer_load_ushort v14, v15, s[28:31], s17 offen
    v_add_u32 v124, 4096, v1
    v_add_u32 v125, 8192, v1
    v_add_u32 v126, 12288, v1
    v_add_u32 v123, s36, v1
    v_add_u32 v120, s37, v1
    v_add_u32 v121, s38, v1
    v_add_u32 v122, s39, v1
    s_mov_b32 s43, 2130706432
    s_mov_b32 s84, 2130706432
    v_mov_b32 v245, 0
    v_mov_b32 v240, 0
    v_mov_b32 v241, 0
    v_mov_b32 v242, 0
    v_mov_b32 v243, 0
L_s6wait:
    s_mov_b64 exec, 1
    s_mov_b32 s72, 524288
L_poll12:
    v_mov_b32 v6, 0
    buffer_atomic_add v6, off, s[48:51], s10 sc0 sc1
    s_sub_u32 s72, s72, 1
    s_cbranch_scc1 L_pollx12
    s_waitcnt vmcnt(0)
    v_cmp_ne_u32 vcc, s22, v6
    s_nop 0
    s_cbranch_vccnz L_poll12
L_pollx12:
    s_mov_b64 exec, -1
    s_branch L_p3
L_end:
    s_waitcnt vmcnt(0) lgkmcnt(0)
L_done:
    s_endpgm
.section .rodata,"a"
.p2align 6
.amdhsa_kernel adaLN_cond__linear_kernel_hedgehog__mixer_gmlp__prompt_kernel
  .amdhsa_next_free_vgpr 512
  .amdhsa_next_free_sgpr 102
  .amdhsa_accum_offset 256
  .amdhsa_group_segment_fixed_size 0
  .amdhsa_kernarg_size 112
  .amdhsa_user_sgpr_count 2
  .amdhsa_user_sgpr_kernarg_segment_ptr 1
  .amdhsa_system_sgpr_workgroup_id_x 1
.end_amdhsa_kernel
```
